```python
import torch

def _softmax(x, axis=-1):
    return torch.softmax(x, dim=axis)
def _gelu(x):
    return torch.nn.functional.gelu(x, approximate="tanh")
def _silu(x):
    return torch.nn.functional.silu(x)
def _sigmoid(x):
    return torch.sigmoid(x)
def _layernorm(x, axis=-1, eps=1e-5):
    m = x.mean(dim=axis, keepdim=True)
    v = x.var(dim=axis, keepdim=True, unbiased=False)
    return (x - m) / torch.sqrt(v + eps)
def _scatter_add(tgt, idx, src, axis=0):
    return tgt.clone().index_add_(axis, idx, src)
def _segment_sum(src, seg, n):
    out = torch.zeros((n,) + src.shape[1:], dtype=src.dtype)
    return out.index_add_(0, seg, src)
def _pad(x, pw):
    flat = tuple(v for pair in reversed(pw) for v in pair)
    return torch.nn.functional.pad(x, flat)

kernel_name = 'recurrent_scan__sliding_block_cached__mixer_channel_mlp__decode'

def setup_inputs():

    _w = (lambda a: (lambda t: t.to(torch.bfloat16) if t.is_floating_point() else t)(torch.as_tensor(a)))
    def _A_setup():
        B, Sq, D = 2, 1, 1024
        Hq, Hkv, Sk, Dh = 32, 4, 32768, 128
        assert Hq % Hkv == 0, (Hq, Hkv)
        return {
            "x": _w((lambda *s: torch.randn(*s, dtype=torch.bfloat16) * 0.1)(B, Sq, D)),
            "k_cache": _w((lambda *s: torch.randn(*s, dtype=torch.bfloat16) * 0.8)(B, Hkv, Sk, Dh)),
            "v_cache": _w((lambda *s: torch.randn(*s, dtype=torch.bfloat16) * 3.2)(B, Hkv, Sk, Dh)),
            "wq": _w((lambda *s: torch.randn(*s, dtype=torch.bfloat16) * 0.8)(D, Hq * Dh) * (D ** -0.5)),
            "wo": _w((lambda *s: torch.randn(*s, dtype=torch.bfloat16) * 3.2)(Hq * Dh, D) * ((Hq * Dh) ** -0.5)),
        }
    _A_in = _A_setup()

    def _B_setup():
        B, S, D, F = 2, 1, 1024, 3584
        return {
            "x": _w((lambda *s: torch.randn(*s, dtype=torch.bfloat16) * 0.1)(B, S, D)),
            "w1": _w((lambda *s: torch.randn(*s, dtype=torch.bfloat16) * 3.2)(D, F) * (D ** -0.5)),
            "b1": _w((lambda *s: torch.randn(*s, dtype=torch.bfloat16) * 3.2)(F)),
            "w2": _w((lambda *s: torch.randn(*s, dtype=torch.bfloat16) * 3.2)(F, D) * (F ** -0.5)),
            "b2": _w((lambda *s: torch.randn(*s, dtype=torch.bfloat16) * 3.2)(D)),
        }
    _B_in = _B_setup()

    return {
        "A_x": _A_in["x"],
        "A_k_cache": _A_in["k_cache"],
        "A_v_cache": _A_in["v_cache"],
        "A_wq": _A_in["wq"],
        "A_wo": _A_in["wo"],
        "B_x": _B_in["x"],
        "B_w1": _B_in["w1"],
        "B_b1": _B_in["b1"],
        "B_w2": _B_in["w2"],
        "B_b2": _B_in["b2"],
    }

def reference(A_x, A_k_cache, A_v_cache, A_wq, A_wo, B_x, B_w1, B_b1, B_w2, B_b2):
    def _A_ref(x, k_cache, v_cache, wq, wo):
        B, Sq, D = x.shape
        Hq, Dh = 32, 128
        Hkv, Sk = k_cache.shape[1], k_cache.shape[2]
        W = min(4096, max(256, Sk // 4))
        rep = Hq // Hkv
        q = (lambda x, *d: x.permute(*d))((x @ wq).reshape(B, Sq, Hq, Dh), 0, 2, 1, 3)
        k = (lambda x, n, axis: torch.repeat_interleave(x, n, dim=axis))(k_cache[:, :, Sk - W:, :], rep, axis=1)
        v = (lambda x, n, axis: torch.repeat_interleave(x, n, dim=axis))(v_cache[:, :, Sk - W:, :], rep, axis=1)
        scores = torch.einsum("bhqd,bhkd->bhqk", q, k) * (Dh ** -0.5)
        p = _softmax(scores, axis=-1)
        o = torch.einsum("bhqk,bhkd->bhqd", p, v)
        return (lambda x, *d: x.permute(*d))(o, 0, 2, 1, 3).reshape(B, Sq, Hq * Dh) @ wo

    def _B_ref(x, w1, b1, w2, b2):
        y = _layernorm(x, axis=-1)
        h = _gelu(torch.einsum("bsd,df->bsf", y, w1) + b1)
        return torch.einsum("bsf,fd->bsd", h, w2) + b2

    x = A_x
    xn = _layernorm(x, axis=-1)
    s = _A_ref(xn, A_k_cache, A_v_cache, A_wq, A_wo)
    g = _silu(_B_ref(xn, B_w1, B_b1, B_w2, B_b2))
    return x + s * g
```

```asm
; @launch grid=(256,1,1) block=(768,1,1) lds=149632
.amdgcn_target "amdgcn-amd-amdhsa--gfx950"
.text
.globl recurrent_scan__sliding_block_cached__mixer_channel_mlp__decode_kernel
.p2align 8
.type recurrent_scan__sliding_block_cached__mixer_channel_mlp__decode_kernel,@function
recurrent_scan__sliding_block_cached__mixer_channel_mlp__decode_kernel:
    s_load_dwordx16 s[4:19], s[0:1], 0
    v_lshrrev_b32 v2, 6, v0
    s_cmpk_ge_u32 s2, 0x100
    v_readfirstlane_b32 s3, v2
    s_cbranch_scc1 Lend
    s_cmp_lt_u32 s3, 4
    s_cbranch_scc1 Lload
    s_getpc_b64 s[46:47]
Lpc:
    s_andn2_b32 s44, s2, 7
    v_add_u32 v4, s44, v2
    v_mul_u32_u24 v4, 48, v4
    global_load_dword v9, v4, s[46:47]
    s_branch Lhelper
Lload:
    s_load_dwordx8 s[20:27], s[0:1], 64
    v_bfe_u32 v4, v0, 3, 3
    v_bitop3_b32 v5, v4, v0, 7 bitop3:0x28
    v_lshlrev_b32 v5, 4, v5
    s_mul_i32 s44, s2, 0x20010
    s_and_b32 s44, s44, 0x80780
    s_mul_i32 s45, s2, 0x80800
    s_and_b32 s45, s45, 4462592
    s_or_b32 s45, s45, s44
    s_lshl_b32 s44, s3, 20
    s_or_b32 s45, s45, s44
    v_lshl_add_u32 v4, v4, 13, s45
    v_lshlrev_b32 v6, 4, v0
    s_lshl_b32 s46, s3, 10
    s_add_u32 m0, s46, 145536
    s_lshl_b32 s48, 1, 16
    s_waitcnt lgkmcnt(0)
    global_load_lds_dwordx4 v6, s[4:5]
    s_lshl_b32 m0, s3, 12
    v_add_u32 v4, v4, v5
    global_load_lds_dwordx4 v4, s[10:11] nt
    s_addk_i32 m0, 0x400
    v_add_u32 v4, s48, v4
    global_load_lds_dwordx4 v4, s[10:11] nt
    s_addk_i32 m0, 0x400
    v_add_u32 v4, s48, v4
    global_load_lds_dwordx4 v4, s[10:11] nt
    s_addk_i32 m0, 0x400
    v_add_u32 v4, s48, v4
    global_load_lds_dwordx4 v4, s[10:11] nt
    s_addk_i32 m0, 13312
    v_xor_b32 v4, 0x430000, v4
    global_load_lds_dwordx4 v4, s[10:11] nt
Lfirst:
    s_addk_i32 m0, 0x400
    v_add_u32 v4, s48, v4
    global_load_lds_dwordx4 v4, s[10:11] nt
    v_and_b32 v1, 63, v0
    s_and_b32 s30, s2, 7
    s_lshr_b32 s31, s2, 3
    s_lshl3_add_u32 s55, s31, s30
    s_mov_b32 s52, 0
    v_lshrrev_b32 v2, 4, v1
    v_and_b32 v3, 15, v1
    v_mov_b32 v7, 131072
    v_mov_b32 v109, 1
    v_mov_b32 v8, 0
    v_lshl_add_u32 v9, v1, 2, v7
    ds_write_b32 v9, v8 offset:14080
    s_lshl_b32 s47, s3, 12
    s_waitcnt lgkmcnt(0)
    s_barrier
    s_mov_b32 s32, s6
    s_mov_b32 s33, s7
    s_mov_b32 s34, 67108864
    s_mov_b32 s35, 0x20000
    s_lshl_b32 s49, s30, 23
    s_lshl_b32 s44, s31, 8
    s_add_u32 s49, s49, s44
    s_lshl_b32 s44, s3, 17
    s_add_u32 s49, s49, s44
    s_and_b32 s44, s31, 1
    s_lshl_b32 s44, s44, 19
    s_add_u32 s49, s49, s44
    s_add_u32 s49, s49, 7340032
    s_xor_b32 s54, s49, 0x80000
    v_xor_b32 v8, v3, v2
    v_lshlrev_b32 v8, 4, v8
    v_lshl_add_u32 v8, v2, 13, v8
    v_xor_b32 v9, 64, v8
    v_xor_b32 v10, 128, v8
    v_xor_b32 v11, 192, v8
    s_waitcnt vmcnt(6)
    s_mov_b64 exec, 1
    ds_add_u32 v7, v109 offset:14080
    s_mov_b64 exec, -1
    s_cmp_ge_u32 s31, 28
    s_cbranch_scc1 Lloada
    s_add_u32 m0, s47, 32768
    s_waitcnt vmcnt(4)
    buffer_load_dwordx4 v8, s[32:35], s49 offen nt lds
    s_add_u32 m0, s47, 18432
    v_add_u32 v4, s48, v4
    s_waitcnt vmcnt(4)
    global_load_lds_dwordx4 v4, s[10:11] nt
    s_add_u32 m0, s47, 33792
    s_add_u32 s45, s49, 32768
    s_waitcnt vmcnt(4)
    buffer_load_dwordx4 v9, s[32:35], s45 offen nt lds
    s_add_u32 m0, s47, 19456
    v_add_u32 v4, s48, v4
    s_waitcnt vmcnt(4)
    global_load_lds_dwordx4 v4, s[10:11] nt
    s_add_u32 m0, s47, 34816
    s_add_u32 s45, s49, 65536
    s_waitcnt vmcnt(4)
    buffer_load_dwordx4 v10, s[32:35], s45 offen nt lds
    s_mov_b32 s36, s8
    s_mov_b32 s37, s9
    s_mov_b32 s38, 67108864
    s_mov_b32 s39, 0x20000
    s_mov_b32 s56, s12
    s_mov_b32 s57, s13
    s_mov_b32 s58, 8388608
    s_mov_b32 s59, 0x20000
    s_lshl_b32 s51, s31, 13
    s_lshl_b32 s44, s30, 8
    s_add_u32 s51, s51, s44
    s_lshl_b32 s44, s3, 20
    s_add_u32 s51, s51, s44
    v_lshlrev_b32 v6, 1, v2
    v_xor_b32 v6, v3, v6
    v_lshlrev_b32 v6, 4, v6
    v_lshl_add_u32 v12, v2, 13, v6
    v_xor_b32 v13, 128, v12
    v_lshl_add_u32 v16, v2, 11, v6
    v_xor_b32 v17, 128, v16
    s_mov_b32 s40, s16
    s_mov_b32 s41, s17
    s_mov_b32 s42, 7340032
    s_mov_b32 s43, 0x20000
    s_mov_b32 s60, s20
    s_mov_b32 s61, s21
    s_mov_b32 s62, 7340032
    s_mov_b32 s63, 0x20000
    s_lshr_b32 s50, s30, 1
    s_mul_i32 s50, s50, 1835008
    s_lshl_b32 s44, s31, 8
    s_add_u32 s50, s50, s44
    s_and_b32 s44, s30, 1
    s_lshl_b32 s44, s44, 7
    s_add_u32 s50, s50, s44
    s_mul_i32 s44, s3, 229376
    s_add_u32 s50, s50, s44
    s_lshl_b32 s53, s31, 18
    s_lshl_b32 s44, s30, 8
    s_add_u32 s53, s53, s44
    s_lshl_b32 s44, s3, 13
    s_add_u32 s53, s53, s44
    v_lshrrev_b32 v14, 3, v1
    v_mul_u32_u24 v14, 7168, v14
    v_add_u32 v14, v14, v5
    s_and_b32 s44, s3, 2
    s_lshl_b32 s44, s44, 6
    v_xor_b32 v18, s44, v16
    s_add_u32 m0, s47, 35840
    s_add_u32 s45, s49, 98304
    s_waitcnt vmcnt(4)
    buffer_load_dwordx4 v11, s[32:35], s45 offen nt lds
    s_add_u32 m0, s47, 65536
    s_waitcnt vmcnt(4)
    buffer_load_dwordx4 v12, s[36:39], s49 offen nt lds
    s_add_u32 m0, s47, 49152
    s_waitcnt vmcnt(4)
    buffer_load_dwordx4 v8, s[32:35], s54 offen nt lds
    s_add_u32 m0, s47, 66560
    s_add_u32 s45, s49, 32768
    s_waitcnt vmcnt(4)
    s_mov_b64 exec, 1
    ds_add_u32 v7, v109 offset:14092
    s_mov_b64 exec, -1
    buffer_load_dwordx4 v13, s[36:39], s45 offen nt lds
    s_add_u32 m0, s47, 50176
    s_add_u32 s45, s54, 32768
    s_waitcnt vmcnt(4)
    buffer_load_dwordx4 v9, s[32:35], s45 offen nt lds
    s_add_u32 m0, s47, 67584
    s_add_u32 s45, s49, 65536
    s_waitcnt vmcnt(4)
    buffer_load_dwordx4 v12, s[36:39], s45 offen nt lds
    s_add_u32 m0, s47, 51200
    s_add_u32 s45, s54, 65536
    s_waitcnt vmcnt(4)
    buffer_load_dwordx4 v10, s[32:35], s45 offen nt lds
    s_add_u32 m0, s47, 68608
    s_add_u32 s45, s49, 98304
    s_waitcnt vmcnt(4)
    buffer_load_dwordx4 v13, s[36:39], s45 offen nt lds
    s_add_u32 m0, s47, 52224
    s_add_u32 s45, s54, 98304
    s_waitcnt vmcnt(4)
    buffer_load_dwordx4 v11, s[32:35], s45 offen nt lds
    s_add_u32 m0, s47, 81920
    s_waitcnt vmcnt(4)
    buffer_load_dwordx4 v12, s[36:39], s54 offen nt lds
    s_add_u32 m0, s47, 82944
    s_add_u32 s45, s54, 32768
    s_waitcnt vmcnt(4)
    buffer_load_dwordx4 v13, s[36:39], s45 offen nt lds
    s_add_u32 m0, s47, 83968
    s_add_u32 s45, s54, 65536
    s_waitcnt vmcnt(4)
    buffer_load_dwordx4 v12, s[36:39], s45 offen nt lds
    s_add_u32 m0, s47, 84992
    s_add_u32 s45, s54, 98304
    s_waitcnt vmcnt(4)
    buffer_load_dwordx4 v13, s[36:39], s45 offen nt lds
    s_add_u32 m0, s47, 98304
    s_waitcnt vmcnt(4)
    s_mov_b64 exec, 1
    ds_add_u32 v7, v109 offset:14100
    s_mov_b64 exec, -1
    buffer_load_dwordx4 v14, s[40:43], s50 offen nt lds
    s_add_u32 m0, s47, 99328
    s_add_u32 s45, s50, 57344
    s_waitcnt vmcnt(4)
    buffer_load_dwordx4 v14, s[40:43], s45 offen nt lds
Lw_1:
    ds_read_b32 v6, v7 offset:14096
    s_add_u32 s52, s52, 1
    s_cmp_lt_u32 s52, 524288
    s_cbranch_scc0 Lexit
    s_waitcnt lgkmcnt(0)
    v_readfirstlane_b32 s44, v6
    s_cmp_ge_u32 s44, 4
    s_cbranch_scc0 Lw_1
    s_add_u32 m0, s47, 100352
    s_add_u32 s45, s50, 114688
    s_waitcnt vmcnt(4)
    buffer_load_dwordx4 v14, s[40:43], s45 offen nt lds
    s_add_u32 m0, s47, 101376
    s_add_u32 s45, s50, 172032
    s_waitcnt vmcnt(4)
    buffer_load_dwordx4 v14, s[40:43], s45 offen nt lds
    s_add_u32 m0, s47, 114688
    s_add_u32 s45, s50, 917504
    s_waitcnt vmcnt(4)
    s_mov_b64 exec, 1
    ds_add_u32 v7, v109 offset:14116
    s_mov_b64 exec, -1
    buffer_load_dwordx4 v14, s[40:43], s45 offen nt lds
    s_add_u32 m0, s47, 0
    s_waitcnt vmcnt(4)
    buffer_load_dwordx4 v16, s[56:59], s51 offen nt lds
    s_add_u32 m0, s47, 115712
    s_add_u32 s45, s50, 974848
    s_waitcnt vmcnt(4)
    buffer_load_dwordx4 v14, s[40:43], s45 offen nt lds
    s_add_u32 m0, s47, 1024
    s_add_u32 s45, s51, 262144
    s_waitcnt vmcnt(4)
    buffer_load_dwordx4 v16, s[56:59], s45 offen nt lds
    s_add_u32 m0, s47, 116736
    s_add_u32 s45, s50, 1032192
    s_waitcnt vmcnt(4)
    buffer_load_dwordx4 v14, s[40:43], s45 offen nt lds
    s_add_u32 m0, s47, 2048
    s_add_u32 s45, s51, 524288
    s_waitcnt vmcnt(4)
    buffer_load_dwordx4 v17, s[56:59], s45 offen nt lds
    s_add_u32 m0, s47, 117760
    s_add_u32 s45, s50, 1089536
    s_waitcnt vmcnt(4)
    buffer_load_dwordx4 v14, s[40:43], s45 offen nt lds
    s_add_u32 m0, s47, 3072
    s_add_u32 s45, s51, 786432
    s_waitcnt vmcnt(4)
    buffer_load_dwordx4 v17, s[56:59], s45 offen nt lds
Lw_2:
    ds_read_b32 v6, v7 offset:14104
    s_add_u32 s52, s52, 1
    s_cmp_lt_u32 s52, 524288
    s_cbranch_scc0 Lexit
    s_waitcnt lgkmcnt(0)
    v_readfirstlane_b32 s44, v6
    s_cmp_ge_u32 s44, 4
    s_cbranch_scc0 Lw_2
    s_add_u32 m0, s47, 16384
    s_add_u32 s45, s51, 4194304
    s_waitcnt vmcnt(4)
    buffer_load_dwordx4 v16, s[56:59], s45 offen nt lds
    s_add_u32 m0, s47, 17408
    s_add_u32 s45, s51, 4456448
    s_waitcnt vmcnt(4)
    buffer_load_dwordx4 v16, s[56:59], s45 offen nt lds
    s_add_u32 m0, s47, 18432
    s_add_u32 s45, s51, 4718592
    s_waitcnt vmcnt(4)
    buffer_load_dwordx4 v17, s[56:59], s45 offen nt lds
    s_add_u32 m0, s47, 19456
    s_add_u32 s45, s51, 4980736
    s_waitcnt vmcnt(4)
    s_mov_b64 exec, 1
    ds_add_u32 v7, v109 offset:14128
    s_mov_b64 exec, -1
    buffer_load_dwordx4 v17, s[56:59], s45 offen nt lds
    s_add_u32 m0, s46, 32768
    s_waitcnt vmcnt(4)
    buffer_load_dwordx4 v18, s[60:63], s53 offen nt lds
    s_add_u32 m0, s46, 40960
    s_add_u32 s45, s53, 65536
    s_waitcnt vmcnt(4)
    buffer_load_dwordx4 v18, s[60:63], s45 offen nt lds
    s_add_u32 m0, s46, 49152
    s_add_u32 s45, s53, 131072
    s_waitcnt vmcnt(4)
    buffer_load_dwordx4 v18, s[60:63], s45 offen nt lds
    s_add_u32 m0, s46, 57344
    s_add_u32 s45, s53, 196608
    s_waitcnt vmcnt(4)
    buffer_load_dwordx4 v18, s[60:63], s45 offen nt lds
    s_add_u32 m0, s46, 36864
    s_add_u32 s45, s53, 32768
    s_waitcnt vmcnt(4)
    s_mov_b64 exec, 1
    ds_add_u32 v7, v109 offset:14132
    s_mov_b64 exec, -1
    buffer_load_dwordx4 v18, s[60:63], s45 offen nt lds
    s_add_u32 m0, s46, 45056
    s_add_u32 s45, s53, 98304
    s_waitcnt vmcnt(4)
    buffer_load_dwordx4 v18, s[60:63], s45 offen nt lds
    s_add_u32 m0, s46, 53248
    s_add_u32 s45, s53, 163840
    buffer_load_dwordx4 v18, s[60:63], s45 offen nt lds
    s_add_u32 m0, s46, 61440
    s_add_u32 s45, s53, 229376
    buffer_load_dwordx4 v18, s[60:63], s45 offen nt lds
    s_waitcnt vmcnt(0)
    s_mov_b64 exec, 1
    ds_add_u32 v7, v109 offset:14124
    s_mov_b64 exec, -1
    s_branch Lexit
Lloada:
    s_add_u32 m0, s47, 32768
    s_waitcnt vmcnt(5)
    buffer_load_dwordx4 v8, s[32:35], s49 offen nt lds
    s_add_u32 m0, s47, 18432
    v_add_u32 v4, s48, v4
    s_waitcnt vmcnt(5)
    global_load_lds_dwordx4 v4, s[10:11] nt
    s_add_u32 m0, s47, 33792
    s_add_u32 s45, s49, 32768
    s_waitcnt vmcnt(5)
    buffer_load_dwordx4 v9, s[32:35], s45 offen nt lds
    s_add_u32 m0, s47, 19456
    v_add_u32 v4, s48, v4
    s_waitcnt vmcnt(5)
    global_load_lds_dwordx4 v4, s[10:11] nt
    s_add_u32 m0, s47, 34816
    s_add_u32 s45, s49, 65536
    s_waitcnt vmcnt(5)
    buffer_load_dwordx4 v10, s[32:35], s45 offen nt lds
    s_add_u32 m0, s47, 35840
    s_add_u32 s45, s49, 98304
    s_waitcnt vmcnt(5)
    buffer_load_dwordx4 v11, s[32:35], s45 offen nt lds
    s_mov_b32 s36, s8
    s_mov_b32 s37, s9
    s_mov_b32 s38, 67108864
    s_mov_b32 s39, 0x20000
    s_mov_b32 s56, s12
    s_mov_b32 s57, s13
    s_mov_b32 s58, 8388608
    s_mov_b32 s59, 0x20000
    s_lshl_b32 s51, s31, 13
    s_lshl_b32 s44, s30, 8
    s_add_u32 s51, s51, s44
    s_lshl_b32 s44, s3, 20
    s_add_u32 s51, s51, s44
    v_lshlrev_b32 v6, 1, v2
    v_xor_b32 v6, v3, v6
    v_lshlrev_b32 v6, 4, v6
    v_lshl_add_u32 v12, v2, 13, v6
    v_xor_b32 v13, 128, v12
    v_lshl_add_u32 v16, v2, 11, v6
    v_xor_b32 v17, 128, v16
    s_add_u32 m0, s47, 65536
    s_waitcnt vmcnt(5)
    buffer_load_dwordx4 v12, s[36:39], s49 offen nt lds
    s_add_u32 m0, s47, 49152
    s_waitcnt vmcnt(5)
    buffer_load_dwordx4 v8, s[32:35], s54 offen nt lds
    s_add_u32 m0, s47, 66560
    s_add_u32 s45, s49, 32768
    s_waitcnt vmcnt(5)
    buffer_load_dwordx4 v13, s[36:39], s45 offen nt lds
    s_add_u32 m0, s47, 50176
    s_add_u32 s45, s54, 32768
    s_waitcnt vmcnt(5)
    s_mov_b64 exec, 1
    ds_add_u32 v7, v109 offset:14092
    s_mov_b64 exec, -1
    buffer_load_dwordx4 v9, s[32:35], s45 offen nt lds
    s_add_u32 m0, s47, 67584
    s_add_u32 s45, s49, 65536
    s_waitcnt vmcnt(5)
    buffer_load_dwordx4 v12, s[36:39], s45 offen nt lds
    s_add_u32 m0, s47, 51200
    s_add_u32 s45, s54, 65536
    s_waitcnt vmcnt(5)
    buffer_load_dwordx4 v10, s[32:35], s45 offen nt lds
    s_add_u32 m0, s47, 68608
    s_add_u32 s45, s49, 98304
    s_waitcnt vmcnt(5)
    buffer_load_dwordx4 v13, s[36:39], s45 offen nt lds
    s_add_u32 m0, s47, 52224
    s_add_u32 s45, s54, 98304
    s_waitcnt vmcnt(5)
    buffer_load_dwordx4 v11, s[32:35], s45 offen nt lds
    s_add_u32 m0, s47, 81920
    s_waitcnt vmcnt(5)
    buffer_load_dwordx4 v12, s[36:39], s54 offen nt lds
    s_add_u32 m0, s47, 82944
    s_add_u32 s45, s54, 32768
    s_waitcnt vmcnt(5)
    buffer_load_dwordx4 v13, s[36:39], s45 offen nt lds
    s_add_u32 m0, s47, 83968
    s_add_u32 s45, s54, 65536
    s_waitcnt vmcnt(5)
    buffer_load_dwordx4 v12, s[36:39], s45 offen nt lds
    s_add_u32 m0, s47, 84992
    s_add_u32 s45, s54, 98304
    s_waitcnt vmcnt(5)
    buffer_load_dwordx4 v13, s[36:39], s45 offen nt lds
Lw_3:
    ds_read_b32 v6, v7 offset:14096
    s_add_u32 s52, s52, 1
    s_cmp_lt_u32 s52, 524288
    s_cbranch_scc0 Lexit
    s_waitcnt lgkmcnt(0)
    v_readfirstlane_b32 s44, v6
    s_cmp_ge_u32 s44, 4
    s_cbranch_scc0 Lw_3
    s_add_u32 m0, s47, 0
    s_waitcnt vmcnt(5)
    buffer_load_dwordx4 v16, s[56:59], s51 offen nt lds
    s_add_u32 m0, s47, 1024
    s_add_u32 s45, s51, 262144
    s_waitcnt vmcnt(5)
    s_mov_b64 exec, 1
    ds_add_u32 v7, v109 offset:14100
    s_mov_b64 exec, -1
    s_mov_b64 exec, 1
    ds_add_u32 v7, v109 offset:14128
    s_mov_b64 exec, -1
    buffer_load_dwordx4 v16, s[56:59], s45 offen nt lds
    s_add_u32 m0, s47, 2048
    s_add_u32 s45, s51, 524288
    s_waitcnt vmcnt(5)
    buffer_load_dwordx4 v17, s[56:59], s45 offen nt lds
    s_waitcnt vmcnt(3)
    s_mov_b64 exec, 1
    ds_add_u32 v7, v109 offset:14116
    s_mov_b64 exec, -1
Lw_4:
    ds_read_b32 v6, v7 offset:14148
    s_add_u32 s52, s52, 1
    s_cmp_lt_u32 s52, 524288
    s_cbranch_scc0 Lexit
    s_waitcnt lgkmcnt(0)
    v_readfirstlane_b32 s44, v6
    s_cmp_ge_u32 s44, 4
    s_cbranch_scc0 Lw_4
    s_add_u32 m0, s47, 3072
    s_add_u32 s45, s51, 786432
    buffer_load_dwordx4 v17, s[56:59], s45 offen nt lds
    s_add_u32 m0, s47, 16384
    s_add_u32 s45, s51, 4194304
    buffer_load_dwordx4 v16, s[56:59], s45 offen nt lds
    s_add_u32 m0, s47, 17408
    s_add_u32 s45, s51, 4456448
    buffer_load_dwordx4 v16, s[56:59], s45 offen nt lds
    s_add_u32 m0, s47, 18432
    s_add_u32 s45, s51, 4718592
    buffer_load_dwordx4 v17, s[56:59], s45 offen nt lds
    s_add_u32 m0, s47, 19456
    s_add_u32 s45, s51, 4980736
    buffer_load_dwordx4 v17, s[56:59], s45 offen nt lds
    s_waitcnt vmcnt(0)
    s_mov_b64 exec, 1
    ds_add_u32 v7, v109 offset:14132
    s_mov_b64 exec, -1
    s_branch Lexit
Lhelper:
    s_barrier
    s_load_dwordx8 s[20:27], s[0:1], 64
    s_load_dwordx2 s[28:29], s[0:1], 96
    v_and_b32 v1, 63, v0
    s_and_b32 s30, s2, 7
    s_lshr_b32 s31, s2, 3
    s_lshl3_add_u32 s55, s31, s30
    s_mov_b32 s52, 0
    v_lshrrev_b32 v2, 4, v1
    v_and_b32 v3, 15, v1
    v_mov_b32 v7, 131072
    v_mov_b32 v109, 1
    s_sub_u32 s3, s3, 4
    s_mov_b32 s39, 0x20000
    s_mov_b32 s43, s39
    s_mov_b32 s38, 2097152
    s_mov_b32 s50, 0xffffff00
    s_mov_b32 s51, 0xff
    s_mov_b32 s59, 0xfffffe00
    v_lshlrev_b32 v111, 4, v1
    s_lshl_b32 s45, s3, 11
    s_add_u32 s45, s45, 131072
    v_add_u32 v110, s45, v111
    s_waitcnt vmcnt(0) lgkmcnt(0)
    s_mov_b32 s36, s28
    s_mov_b32 s37, s29
    s_cmp_ge_u32 s3, 2
    s_cbranch_scc1 Lh23
    s_setprio 3
Lw_5:
    ds_read_b32 v6, v7 offset:14080
    ds_read_b128 v[16:19], v110 offset:14464
    ds_read_b128 v[20:23], v110 offset:15488
    s_add_u32 s52, s52, 1
    s_cmp_lt_u32 s52, 524288
    s_cbranch_scc0 Lexit
    s_waitcnt lgkmcnt(0)
    v_readfirstlane_b32 s44, v6
    s_cmp_ge_u32 s44, 4
    s_cbranch_scc0 Lw_5
    s_mov_b32 s62, 0
Lln:
    v_lshlrev_b32 v32, 16, v16
    v_and_b32 v33, 0xffff0000, v16
    v_lshlrev_b32 v34, 16, v17
    v_and_b32 v35, 0xffff0000, v17
    v_lshlrev_b32 v36, 16, v18
    v_and_b32 v37, 0xffff0000, v18
    v_lshlrev_b32 v38, 16, v19
    v_and_b32 v39, 0xffff0000, v19
    v_lshlrev_b32 v40, 16, v20
    v_and_b32 v41, 0xffff0000, v20
    v_lshlrev_b32 v42, 16, v21
    v_and_b32 v43, 0xffff0000, v21
    v_lshlrev_b32 v44, 16, v22
    v_and_b32 v45, 0xffff0000, v22
    v_lshlrev_b32 v46, 16, v23
    v_and_b32 v47, 0xffff0000, v23
    v_pk_add_f32 v[48:49], v[32:33], v[34:35]
    v_pk_add_f32 v[50:51], v[36:37], v[38:39]
    v_pk_add_f32 v[52:53], v[40:41], v[42:43]
    v_pk_add_f32 v[54:55], v[44:45], v[46:47]
    v_pk_add_f32 v[48:49], v[48:49], v[50:51]
    v_pk_add_f32 v[52:53], v[52:53], v[54:55]
    v_pk_add_f32 v[48:49], v[48:49], v[52:53]
    v_add_f32 v8, v48, v49
    s_nop 1
    v_add_f32 v8, v8, v8 quad_perm:[1,0,3,2] row_mask:0xf bank_mask:0xf
    s_nop 1
    v_add_f32 v8, v8, v8 quad_perm:[2,3,0,1] row_mask:0xf bank_mask:0xf
    s_nop 1
    v_add_f32 v8, v8, v8 row_half_mirror row_mask:0xf bank_mask:0xf
    s_nop 1
    v_add_f32 v8, v8, v8 row_ror:8 row_mask:0xf bank_mask:0xf
    v_mov_b32 v9, v8
    s_nop 1
    v_permlane16_swap_b32 v9, v8
    v_add_f32 v8, v8, v9
    v_mov_b32 v9, v8
    s_nop 1
    v_permlane32_swap_b32 v9, v8
    v_add_f32 v8, v8, v9
    v_mul_f32 v8, 0x3a800000, v8
    v_pk_add_f32 v[48:49], v[32:33], v[8:9] op_sel_hi:[1,0] neg_lo:[0,1] neg_hi:[0,1]
    v_pk_add_f32 v[50:51], v[34:35], v[8:9] op_sel_hi:[1,0] neg_lo:[0,1] neg_hi:[0,1]
    v_pk_add_f32 v[52:53], v[36:37], v[8:9] op_sel_hi:[1,0] neg_lo:[0,1] neg_hi:[0,1]
    v_pk_add_f32 v[54:55], v[38:39], v[8:9] op_sel_hi:[1,0] neg_lo:[0,1] neg_hi:[0,1]
    v_pk_add_f32 v[56:57], v[40:41], v[8:9] op_sel_hi:[1,0] neg_lo:[0,1] neg_hi:[0,1]
    v_pk_add_f32 v[58:59], v[42:43], v[8:9] op_sel_hi:[1,0] neg_lo:[0,1] neg_hi:[0,1]
    v_pk_add_f32 v[60:61], v[44:45], v[8:9] op_sel_hi:[1,0] neg_lo:[0,1] neg_hi:[0,1]
    v_pk_add_f32 v[62:63], v[46:47], v[8:9] op_sel_hi:[1,0] neg_lo:[0,1] neg_hi:[0,1]
    v_pk_mul_f32 v[10:11], v[48:49], v[48:49]
    v_pk_mul_f32 v[12:13], v[50:51], v[50:51]
    v_pk_fma_f32 v[10:11], v[52:53], v[52:53], v[10:11]
    v_pk_fma_f32 v[12:13], v[54:55], v[54:55], v[12:13]
    v_pk_fma_f32 v[10:11], v[56:57], v[56:57], v[10:11]
    v_pk_fma_f32 v[12:13], v[58:59], v[58:59], v[12:13]
    v_pk_fma_f32 v[10:11], v[60:61], v[60:61], v[10:11]
    v_pk_fma_f32 v[12:13], v[62:63], v[62:63], v[12:13]
    v_pk_add_f32 v[10:11], v[10:11], v[12:13]
    v_add_f32 v10, v10, v11
    v_cvt_pk_bf16_f32 v8, 0, v8
    s_nop 0
    v_add_f32 v10, v10, v10 quad_perm:[1,0,3,2] row_mask:0xf bank_mask:0xf
    s_nop 1
    v_add_f32 v10, v10, v10 quad_perm:[2,3,0,1] row_mask:0xf bank_mask:0xf
    s_nop 1
    v_add_f32 v10, v10, v10 row_half_mirror row_mask:0xf bank_mask:0xf
    s_nop 1
    v_add_f32 v10, v10, v10 row_ror:8 row_mask:0xf bank_mask:0xf
    v_mov_b32 v11, v10
    s_nop 1
    v_permlane16_swap_b32 v11, v10
    v_add_f32 v10, v10, v11
    v_mov_b32 v11, v10
    s_nop 1
    v_permlane32_swap_b32 v11, v10
    v_add_f32 v10, v10, v11
    v_mul_f32 v10, 0x3a800000, v10
    v_cvt_pk_bf16_f32 v10, 0, v10
    v_add_f32 v10, 0x3727c5ac, v10
    v_cvt_pk_bf16_f32 v10, 0, v10
    v_sqrt_f32 v10, v10
    v_pk_add_f32 v[32:33], v[32:33], v[8:9] op_sel_hi:[1,0] neg_lo:[0,1] neg_hi:[0,1]
    v_pk_add_f32 v[34:35], v[34:35], v[8:9] op_sel_hi:[1,0] neg_lo:[0,1] neg_hi:[0,1]
    v_pk_add_f32 v[36:37], v[36:37], v[8:9] op_sel_hi:[1,0] neg_lo:[0,1] neg_hi:[0,1]
    v_pk_add_f32 v[38:39], v[38:39], v[8:9] op_sel_hi:[1,0] neg_lo:[0,1] neg_hi:[0,1]
    v_pk_add_f32 v[40:41], v[40:41], v[8:9] op_sel_hi:[1,0] neg_lo:[0,1] neg_hi:[0,1]
    v_pk_add_f32 v[42:43], v[42:43], v[8:9] op_sel_hi:[1,0] neg_lo:[0,1] neg_hi:[0,1]
    v_pk_add_f32 v[44:45], v[44:45], v[8:9] op_sel_hi:[1,0] neg_lo:[0,1] neg_hi:[0,1]
    v_pk_add_f32 v[46:47], v[46:47], v[8:9] op_sel_hi:[1,0] neg_lo:[0,1] neg_hi:[0,1]
    v_cvt_pk_bf16_f32 v10, 0, v10
    v_rcp_f32 v10, v10
    v_cvt_pk_bf16_f32 v16, v32, v33
    v_cvt_pk_bf16_f32 v17, v34, v35
    v_cvt_pk_bf16_f32 v18, v36, v37
    v_cvt_pk_bf16_f32 v19, v38, v39
    v_cvt_pk_bf16_f32 v20, v40, v41
    v_cvt_pk_bf16_f32 v21, v42, v43
    v_cvt_pk_bf16_f32 v22, v44, v45
    v_cvt_pk_bf16_f32 v23, v46, v47
    v_lshlrev_b32 v32, 16, v16
    v_and_b32 v33, 0xffff0000, v16
    v_lshlrev_b32 v34, 16, v17
    v_and_b32 v35, 0xffff0000, v17
    v_lshlrev_b32 v36, 16, v18
    v_and_b32 v37, 0xffff0000, v18
    v_lshlrev_b32 v38, 16, v19
    v_and_b32 v39, 0xffff0000, v19
    v_lshlrev_b32 v40, 16, v20
    v_and_b32 v41, 0xffff0000, v20
    v_lshlrev_b32 v42, 16, v21
    v_and_b32 v43, 0xffff0000, v21
    v_lshlrev_b32 v44, 16, v22
    v_and_b32 v45, 0xffff0000, v22
    v_lshlrev_b32 v46, 16, v23
    v_and_b32 v47, 0xffff0000, v23
    v_pk_mul_f32 v[32:33], v[32:33], v[10:11] op_sel_hi:[1,0]
    v_pk_mul_f32 v[34:35], v[34:35], v[10:11] op_sel_hi:[1,0]
    v_pk_mul_f32 v[36:37], v[36:37], v[10:11] op_sel_hi:[1,0]
    v_pk_mul_f32 v[38:39], v[38:39], v[10:11] op_sel_hi:[1,0]
    v_pk_mul_f32 v[40:41], v[40:41], v[10:11] op_sel_hi:[1,0]
    v_pk_mul_f32 v[42:43], v[42:43], v[10:11] op_sel_hi:[1,0]
    v_pk_mul_f32 v[44:45], v[44:45], v[10:11] op_sel_hi:[1,0]
    v_pk_mul_f32 v[46:47], v[46:47], v[10:11] op_sel_hi:[1,0]
    v_cvt_pk_bf16_f32 v16, v32, v33
    v_cvt_pk_bf16_f32 v17, v34, v35
    v_cvt_pk_bf16_f32 v18, v36, v37
    v_cvt_pk_bf16_f32 v19, v38, v39
    v_cvt_pk_bf16_f32 v20, v40, v41
    v_cvt_pk_bf16_f32 v21, v42, v43
    v_cvt_pk_bf16_f32 v22, v44, v45
    v_cvt_pk_bf16_f32 v23, v46, v47
    ds_write_b128 v110, v[16:19] offset:0
    ds_write_b128 v110, v[20:23] offset:1024
    s_cmp_eq_u32 s62, 1
    s_cbranch_scc1 Lln2
    s_mov_b64 exec, 1
    ds_add_u32 v7, v109 offset:14084
    s_mov_b64 exec, -1
    s_setprio 0
    s_mov_b32 s62, 1
    v_add_u32 v110, 4096, v110
    s_branch Lln
Lln2:
    s_mov_b64 exec, 1
    ds_add_u32 v7, v109 offset:14088
    s_mov_b64 exec, -1
    s_branch Lattn
Lh23:
    s_cmp_ge_u32 s3, 4
    s_cbranch_scc1 Lgemv
    s_cmp_eq_u32 s3, 2
    s_cbranch_scc0 Lattn
    s_cmp_lt_u32 s30, 4
    s_cbranch_scc0 Lnt1
    s_lshl_b32 s45, s55, 7
    s_add_u32 s45, s45, 32768
    s_add_u32 s46, s28, s45
    s_addc_u32 s47, s29, 0
    s_load_dword s61, s[46:47], 0 glc
    s_load_dword s60, s[46:47], 64 glc
Lnt1:
    s_cmp_lt_u32 s2, 32
    s_cbranch_scc0 Lnt2
    s_lshl_b32 s45, s2, 7
    s_add_u32 s45, s45, 16384
    s_add_u32 s48, s28, s45
    s_addc_u32 s49, s29, 0
    s_load_dword s62, s[48:49], 0 glc
Lnt2:
    s_waitcnt lgkmcnt(0)
    s_branch Lattn
Lgemv:
    s_load_dword s94, s[28:29], 0
    s_sub_u32 s3, s3, 4
    v_lshrrev_b32 v4, 2, v3
    v_and_b32 v6, 1, v2
    v_lshrrev_b32 v13, 1, v2
    v_lshlrev_b32 v13, 2, v13
    v_add_lshl_u32 v13, v13, v6, 2
    v_add_u32 v5, v13, v4
    v_bfe_u32 v14, v1, 1, 1
    v_and_b32 v15, 1, v1
    v_lshl_add_u32 v8, v6, 2, v4
    s_lshl_b32 s44, s3, 1
    v_add_u32 v9, s44, v14
    v_xor_b32 v8, v8, v9
    v_lshlrev_b32 v8, 4, v8
    v_lshl_add_u32 v8, v5, 7, v8
    v_lshl_add_u32 v8, v15, 3, v8
    v_add_u32 v88, 98304, v8
    v_and_b32 v4, 1, v4
    v_lshlrev_b32 v4, 11, v4
    v_lshl_add_u32 v4, v13, 1, v4
    s_lshr_b32 s53, s30, 2
    s_lshl_b32 s53, s53, 1
    s_lshr_b32 s44, s2, 7
    s_add_u32 s53, s53, s44
    s_lshl_b32 s45, s53, 6
    s_and_b32 s44, s2, 8
    s_lshl_b32 s44, s44, 7
    s_add_u32 s45, s45, s44
    s_add_u32 s45, s45, 131072
    v_add_u32 v11, s45, v4
    v_xor_b32 v10, 1024, v11
    s_lshr_b32 s45, s30, 1
    s_lshl_b32 s45, s45, 9
    s_add_u32 s45, s45, 135168
    v_add_u32 v12, s45, v4
    v_lshlrev_b32 v14, 16, v2
    v_lshl_add_u32 v14, v3, 2, v14
    v_lshlrev_b32 v89, 9, v1
    v_lshlrev_b32 v90, 2, v1
    v_lshlrev_b32 v91, 7, v1
    s_and_b32 s45, s30, 3
    s_lshl_b32 s45, s45, 14
    s_lshl_b32 s44, s53, 12
    s_add_u32 s45, s45, s44
    s_and_b32 s44, s2, 0x78
    s_lshl_b32 s44, s44, 5
    s_add_u32 s45, s45, s44
    s_lshl_b32 s44, s3, 6
    s_add_u32 s45, s45, s44
    s_add_u32 s45, s45, 65536
    s_and_b32 s46, s2, 0x1b
    s_lshl_b32 s46, s46, 7
    s_lshr_b32 s44, s30, 2
    s_lshl_b32 s44, s44, 5
    s_add_u32 s46, s46, s44
    s_lshr_b32 s44, s2, 5
    s_lshl_b32 s44, s44, 2
    s_add_u32 s46, s46, s44
    s_add_u32 s46, s46, 16384
    v_lshrrev_b32 v4, 3, v3
    v_and_b32 v5, 3, v3
    v_lshlrev_b32 v4, 4, v4
    v_lshl_add_u32 v4, v5, 2, v4
    v_add_lshl_u32 v4, v4, v2, 1
    s_mov_b32 s40, s18
    s_mov_b32 s41, s19
    s_mov_b32 s42, 7168
    s_lshl_b32 s49, s3, 6
    s_lshl_b32 s44, s31, 8
    s_add_u32 s44, s44, s49
    buffer_load_ushort v106, v4, s[40:43], s44 offen
    v_bfe_u32 v6, v3, 2, 1
    v_lshl_add_u32 v4, v6, 8, v4
    s_add_u32 s49, s49, 131072
    v_add_u32 v114, s49, v4
    s_getreg_b32 s49, hwreg(HW_REG_XCC_ID, 0, 4)
    v_lshrrev_b32 v95, v5, s49
    v_and_b32 v95, 1, v95
    v_lshlrev_b32 v95, 8, v95
Lw_6:
    ds_read_b32 v6, v7 offset:14084
    s_add_u32 s52, s52, 1
    s_cmp_lt_u32 s52, 524288
    s_cbranch_scc0 Lexit
    s_waitcnt lgkmcnt(0)
    v_readfirstlane_b32 s44, v6
    s_cmp_ge_u32 s44, 2
    s_cbranch_scc0 Lw_6
    ds_read2_b64 v[16:19], v11 offset0:0 offset1:2
    ds_read2_b64 v[20:23], v11 offset0:32 offset1:34
    ds_read2_b64 v[24:27], v11 offset0:64 offset1:66
    ds_read2_b64 v[28:31], v11 offset0:96 offset1:98
    ds_read2_b64 v[32:35], v10 offset0:0 offset1:2
    ds_read2_b64 v[36:39], v10 offset0:32 offset1:34
    ds_read2_b64 v[40:43], v10 offset0:64 offset1:66
    ds_read2_b64 v[44:47], v10 offset0:96 offset1:98
    s_add_u32 s94, s94, 0x9e3779b1
    s_mov_b32 s95, s94
    v_mov_b32 v108, s94
    v_and_or_b32 v112, v108, s51, v95
    s_setprio 2
Lw_7:
    ds_read_b32 v6, v7 offset:14092
    s_add_u32 s52, s52, 1
    s_cmp_lt_u32 s52, 524288
    s_cbranch_scc0 Lexit
    s_waitcnt lgkmcnt(0)
    v_readfirstlane_b32 s44, v6
    s_cmp_ge_u32 s44, 4
    s_cbranch_scc0 Lw_7
    ds_read_b64_tr_b16 v[48:49], v8 offset:0
    ds_read_b64_tr_b16 v[50:51], v8 offset:1024
    ds_read_b64_tr_b16 v[52:53], v8 offset:4096
    ds_read_b64_tr_b16 v[54:55], v8 offset:5120
    ds_read_b64_tr_b16 v[56:57], v8 offset:8192
    ds_read_b64_tr_b16 v[58:59], v8 offset:9216
    ds_read_b64_tr_b16 v[60:61], v8 offset:12288
    ds_read_b64_tr_b16 v[62:63], v8 offset:13312
    ds_read_b64_tr_b16 v[64:65], v8 offset:16384
    ds_read_b64_tr_b16 v[66:67], v8 offset:17408
    s_cmp_eq_u32 s3, 0
    s_cbranch_scc0 Lh_8
    s_mov_b64 exec, 3
    buffer_store_dword v108, v89, s[36:39], s46 offen sc1
    s_mov_b64 exec, -1
Lh_8:
    s_waitcnt lgkmcnt(8)
    v_mfma_f32_16x16x32_bf16 v[80:83], v[16:19], v[48:51], 0
    ds_read_b64_tr_b16 v[68:69], v8 offset:20480
    ds_read_b64_tr_b16 v[70:71], v8 offset:21504
    s_waitcnt lgkmcnt(8)
    v_mfma_f32_16x16x32_bf16 v[80:83], v[20:23], v[52:55], v[80:83]
    ds_read_b64_tr_b16 v[72:73], v8 offset:24576
    ds_read_b64_tr_b16 v[74:75], v8 offset:25600
    s_waitcnt lgkmcnt(8)
    v_mfma_f32_16x16x32_bf16 v[80:83], v[24:27], v[56:59], v[80:83]
    ds_read_b64_tr_b16 v[76:77], v8 offset:28672
    ds_read_b64_tr_b16 v[78:79], v8 offset:29696
    s_waitcnt lgkmcnt(8)
    v_mfma_f32_16x16x32_bf16 v[80:83], v[28:31], v[60:63], v[80:83]
    s_waitcnt lgkmcnt(6)
    v_mfma_f32_16x16x32_bf16 v[80:83], v[32:35], v[64:67], v[80:83]
    s_waitcnt lgkmcnt(4)
    v_mfma_f32_16x16x32_bf16 v[80:83], v[36:39], v[68:71], v[80:83]
    s_waitcnt lgkmcnt(2)
    v_mfma_f32_16x16x32_bf16 v[80:83], v[40:43], v[72:75], v[80:83]
    s_waitcnt lgkmcnt(0)
    v_mfma_f32_16x16x32_bf16 v[80:83], v[44:47], v[76:79], v[80:83]
    s_mov_b64 exec, 1
    ds_add_u32 v7, v109 offset:14096
    s_mov_b64 exec, -1
    s_mov_b32 exec_hi, 0
    s_nop 3
    v_bfi_b32 v92, s59, v80, v112
    buffer_store_dword v92, v14, s[36:39], s45 offen sc1
    s_mov_b64 exec, -1
    s_setprio 0
    v_and_b32 v4, 1, v1
    v_lshlrev_b32 v13, 8, v4
    v_lshl_add_u32 v13, v2, 4, v13
    v_add_u32 v13, 131072, v13
    v_bfe_u32 v5, v1, 1, 1
    v_lshl_add_u32 v5, v5, 2, v2
    v_lshlrev_b32 v5, 6, v5
    v_lshl_add_u32 v15, v4, 4, v5
    v_add_u32 v112, 64, v108
    s_mov_b32 s56, 0x000c000c
    s_mov_b32 s57, s56
    s_mov_b32 s92, 0x000f000f
    s_mov_b32 s93, s92
    s_lshl_b32 s58, s30, 17
    s_lshl_b32 s44, s3, 9
    s_add_u32 s58, s58, s44
    s_lshl_b32 s44, s31, 12
    s_add_u32 s58, s58, s44
    s_add_u32 s58, s58, 1048608
    s_cmp_ge_u32 s31, 28
    s_cbranch_scc1 Lagent
    v_lshrrev_b32 v4, 2, v3
    v_and_b32 v5, 1, v2
    v_lshl_add_u32 v5, v5, 2, v4
    v_lshlrev_b32 v5, 1, v5
    v_bfe_u32 v6, v1, 1, 1
    s_lshl_b32 s44, s3, 2
    v_add_u32 v6, s44, v6
    v_xor_b32 v9, v5, v6
    v_lshlrev_b32 v9, 4, v9
    v_lshl_add_u32 v4, v2, 3, v4
    v_lshl_add_u32 v9, v4, 8, v9
    v_and_b32 v5, 1, v1
    v_lshl_add_u32 v9, v5, 3, v9
    v_xor_b32 v10, 32, v9
    s_lshl_b32 s45, s31, 12
    s_lshl_b32 s44, s30, 9
    s_add_u32 s45, s45, s44
    s_lshl_b32 s44, s3, 7
    s_add_u32 s45, s45, s44
    s_add_u32 s45, s45, 262144
    s_lshl_b32 s47, s31, 12
    s_lshl_b32 s44, s3, 8
    s_add_u32 s47, s47, s44
    s_add_u32 s47, s47, 262144
    s_lshl_b32 s46, s31, 10
    s_lshl_b32 s44, s30, 2
    s_add_u32 s46, s46, s44
    s_add_u32 s46, s46, 32768
    s_and_b32 s48, s55, 251
    s_lshl_b32 s48, s48, 7
    s_add_u32 s48, s48, 32768
    s_add_u32 s20, s28, s48
    s_addc_u32 s21, s29, 0
    v_lshlrev_b32 v11, 10, v2
    v_lshl_add_u32 v11, v3, 4, v11
    v_mov_b32 v97, 0xc0135761
    v_mov_b32 v113, 0x10000
Lw_9:
    ds_read_b32 v6, v7 offset:14088
    s_add_u32 s52, s52, 1
    s_cmp_lt_u32 s52, 524288
    s_cbranch_scc0 Lexit
    s_waitcnt lgkmcnt(0)
    v_readfirstlane_b32 s44, v6
    s_cmp_ge_u32 s44, 2
    s_cbranch_scc0 Lw_9
    ds_read2_b64 v[16:19], v12 offset0:0 offset1:2
    ds_read2_b64 v[20:23], v12 offset0:8 offset1:10
    ds_read2_b64 v[24:27], v12 offset0:16 offset1:18
    ds_read2_b64 v[28:31], v12 offset0:24 offset1:26
    ds_read2_b64 v[32:35], v12 offset0:32 offset1:34
    ds_read2_b64 v[36:39], v12 offset0:40 offset1:42
    ds_read2_b64 v[40:43], v12 offset0:48 offset1:50
    ds_read2_b64 v[44:47], v12 offset0:56 offset1:58
    s_waitcnt vmcnt(0)
    v_lshlrev_b32 v106, 16, v106
Lw_10:
    ds_read_b32 v6, v7 offset:14128
    s_add_u32 s52, s52, 1
    s_cmp_lt_u32 s52, 524288
    s_cbranch_scc0 Lexit
    s_waitcnt lgkmcnt(0)
    v_readfirstlane_b32 s44, v6
    s_cmp_ge_u32 s44, 4
    s_cbranch_scc0 Lw_10
    ds_read_b64_tr_b16 v[48:49], v88 offset:0
    ds_read_b64_tr_b16 v[50:51], v88 offset:1024
    ds_read_b64_tr_b16 v[52:53], v88 offset:4096
    ds_read_b64_tr_b16 v[54:55], v88 offset:5120
    ds_read_b64_tr_b16 v[56:57], v88 offset:8192
    ds_read_b64_tr_b16 v[58:59], v88 offset:9216
    ds_read_b64_tr_b16 v[60:61], v88 offset:12288
    ds_read_b64_tr_b16 v[62:63], v88 offset:13312
    ds_read_b64_tr_b16 v[64:65], v88 offset:16384
    ds_read_b64_tr_b16 v[66:67], v88 offset:17408
    s_cmp_eq_u32 s3, 0
    s_cbranch_scc0 Lh_11
    s_mov_b64 exec, 15
    buffer_store_dword v108, v91, s[36:39], s46 offen sc1
    s_mov_b64 exec, -1
Lh_11:
    s_waitcnt lgkmcnt(8)
    v_mfma_f32_16x16x32_bf16 v[80:83], v[16:19], v[48:51], 0
    ds_read_b64_tr_b16 v[68:69], v88 offset:20480
    ds_read_b64_tr_b16 v[70:71], v88 offset:21504
    s_waitcnt lgkmcnt(8)
    v_mfma_f32_16x16x32_bf16 v[80:83], v[20:23], v[52:55], v[80:83]
    ds_read_b64_tr_b16 v[72:73], v88 offset:24576
    ds_read_b64_tr_b16 v[74:75], v88 offset:25600
    s_waitcnt lgkmcnt(8)
    v_mfma_f32_16x16x32_bf16 v[80:83], v[24:27], v[56:59], v[80:83]
    ds_read_b64_tr_b16 v[76:77], v88 offset:28672
    ds_read_b64_tr_b16 v[78:79], v88 offset:29696
    s_waitcnt lgkmcnt(8)
    v_mfma_f32_16x16x32_bf16 v[80:83], v[28:31], v[60:63], v[80:83]
    s_waitcnt lgkmcnt(6)
    v_mfma_f32_16x16x32_bf16 v[80:83], v[32:35], v[64:67], v[80:83]
    s_waitcnt lgkmcnt(4)
    v_mfma_f32_16x16x32_bf16 v[80:83], v[36:39], v[68:71], v[80:83]
    s_waitcnt lgkmcnt(2)
    v_mfma_f32_16x16x32_bf16 v[80:83], v[40:43], v[72:75], v[80:83]
    s_waitcnt lgkmcnt(0)
    v_mfma_f32_16x16x32_bf16 v[80:83], v[44:47], v[76:79], v[80:83]
    s_mov_b32 exec_hi, 0
    s_nop 6
    v_bfi_b32 v92, s50, v80, v108
    buffer_store_dword v92, v90, s[36:39], s45 offen sc1
    s_mov_b64 exec, -1
    s_cmp_eq_u32 s3, 0
    s_cbranch_scc0 Lhwait
Lhh:
    s_load_dwordx8 s[4:11], s[20:21], 0 glc
    s_add_u32 s52, s52, 1
    s_cmp_lt_u32 s52, 524288
    s_cbranch_scc0 Lexit
    s_waitcnt lgkmcnt(0)
    s_xor_b64 s[4:5], s[4:5], s[94:95]
    s_xor_b64 s[6:7], s[6:7], s[94:95]
    s_xor_b64 s[8:9], s[8:9], s[94:95]
    s_xor_b64 s[10:11], s[10:11], s[94:95]
    s_or_b64 s[4:5], s[4:5], s[8:9]
    s_or_b64 s[6:7], s[6:7], s[10:11]
    s_or_b64 s[4:5], s[4:5], s[6:7]
    s_cbranch_scc1 Lhh
    s_mov_b64 exec, 1
    ds_add_u32 v7, v109 offset:14136
    s_mov_b64 exec, -1
Lhgo:
    s_setprio 2
    buffer_load_dwordx4 v[32:35], v11, s[36:39], s47 offen sc1
    s_waitcnt vmcnt(0)
Lhg:
    v_bitop3_b32 v4, v32, v33, v108 bitop3:0x7e
    v_bitop3_b32 v40, v34, v35, v108 bitop3:0x7e
    v_bitop3_b32 v4, v4, v40, s51 bitop3:0xa8
    v_cmp_ne_u32 vcc, 0, v4
    s_cbranch_vccnz Lhg_again
    v_and_b32 v32, s50, v32
    v_and_b32 v33, s50, v33
    v_and_b32 v34, s50, v34
    v_and_b32 v35, s50, v35
    v_permlane16_swap_b32 v32, v33
    s_nop 0
    v_permlane16_swap_b32 v34, v35
    v_add_f32 v32, v32, v33
    v_add_f32 v34, v34, v35
    s_nop 1
    v_permlane32_swap_b32 v32, v34
    v_add_f32 v32, v32, v34
    v_cvt_pk_bf16_f32 v32, 0, v32
    v_add_f32 v32, v32, v106
    v_cvt_pk_bf16_f32 v32, 0, v32
    v_mul_f32 v36, v32, v32
    v_fmac_f32 v97, 0xbdd2d3e8, v36
    v_mul_f32 v97, v97, v32
    v_exp_f32 v97, v97
    s_nop 0
    v_add_f32 v97, 1.0, v97
    v_rcp_f32 v97, v97
    s_nop 0
    v_mul_f32 v32, v32, v97
    v_cvt_pk_bf16_f32 v32, v32, v32
    ds_write_b16 v114, v32 offset:13568
    s_mov_b64 exec, 1
    ds_add_u32 v7, v113 offset:14124
    s_mov_b64 exec, -1
Lw_12:
    ds_read_b64 v[4:5], v7 offset:14120
    ds_read_b128 v[16:19], v13 offset:13568
    ds_read_b128 v[20:23], v13 offset:13632
    ds_read_b128 v[24:27], v13 offset:13696
    ds_read_b128 v[28:31], v13 offset:13760
    s_add_u32 s52, s52, 1
    s_cmp_lt_u32 s52, 524288
    s_cbranch_scc0 Lexit
    s_waitcnt lgkmcnt(4)
    v_readfirstlane_b32 s44, v5
    s_bitcmp1_b32 s44, 18
    s_cbranch_scc0 Lw_12
    s_bitcmp1_b32 s44, 2
    s_cbranch_scc1 Lw2ok
Lw_13:
    ds_read_b64 v[4:5], v7 offset:14120
    s_add_u32 s52, s52, 1
    s_cmp_lt_u32 s52, 524288
    s_cbranch_scc0 Lexit
    s_waitcnt lgkmcnt(0)
    v_readfirstlane_b32 s44, v5
    s_bitcmp1_b32 s44, 2
    s_cbranch_scc0 Lw_13
Lw2ok:
    ds_read_b64_tr_b16 v[48:49], v9 offset:32768
    ds_read_b64_tr_b16 v[50:51], v9 offset:33792
    ds_read_b64_tr_b16 v[52:53], v9 offset:40960
    ds_read_b64_tr_b16 v[54:55], v9 offset:41984
    ds_read_b64_tr_b16 v[56:57], v9 offset:49152
    ds_read_b64_tr_b16 v[58:59], v9 offset:50176
    ds_read_b64_tr_b16 v[60:61], v9 offset:57344
    ds_read_b64_tr_b16 v[62:63], v9 offset:58368
    ds_read_b64_tr_b16 v[64:65], v10 offset:32768
    ds_read_b64_tr_b16 v[66:67], v10 offset:33792
    s_waitcnt lgkmcnt(8)
    v_mfma_f32_16x16x32_bf16 v[80:83], v[48:51], v[16:19], 0
    ds_read_b64_tr_b16 v[68:69], v10 offset:40960
    ds_read_b64_tr_b16 v[70:71], v10 offset:41984
    s_waitcnt lgkmcnt(8)
    v_mfma_f32_16x16x32_bf16 v[80:83], v[52:55], v[20:23], v[80:83]
    ds_read_b64_tr_b16 v[72:73], v10 offset:49152
    ds_read_b64_tr_b16 v[74:75], v10 offset:50176
    s_waitcnt lgkmcnt(8)
    v_mfma_f32_16x16x32_bf16 v[80:83], v[56:59], v[24:27], v[80:83]
    ds_read_b64_tr_b16 v[76:77], v10 offset:57344
    ds_read_b64_tr_b16 v[78:79], v10 offset:58368
    s_waitcnt lgkmcnt(8)
    v_mfma_f32_16x16x32_bf16 v[80:83], v[60:63], v[28:31], v[80:83]
    s_waitcnt lgkmcnt(6)
    v_mfma_f32_16x16x32_bf16 v[84:87], v[64:67], v[16:19], 0
    s_waitcnt lgkmcnt(4)
    v_mfma_f32_16x16x32_bf16 v[84:87], v[68:71], v[20:23], v[84:87]
    s_waitcnt lgkmcnt(2)
    v_mfma_f32_16x16x32_bf16 v[84:87], v[72:75], v[24:27], v[84:87]
    s_waitcnt lgkmcnt(0)
    v_mfma_f32_16x16x32_bf16 v[84:87], v[76:79], v[28:31], v[84:87]
    v_readfirstlane_b32 s63, v4
    s_andn2_b32 s44, 0x100, s44
    v_bfi_b32 v100, s50, v80, v112
    v_bfi_b32 v101, s50, v81, v112
    v_bfi_b32 v102, s50, v82, v112
    v_bfi_b32 v103, s50, v83, v112
    s_mov_b64 exec, s[56:57]
    s_or_b32 s44, s44, s63
    v_bfi_b32 v100, s50, v84, v112
    v_bfi_b32 v101, s50, v85, v112
    v_bfi_b32 v102, s50, v86, v112
    v_bfi_b32 v103, s50, v87, v112
    s_mov_b64 exec, s[92:93]
    s_cbranch_scc1 Lmow
    buffer_store_dwordx4 v[100:103], v15, s[36:39], s58 offen
Lmfin:
    s_mov_b64 exec, 1
    ds_add_u32 v7, v109 offset:14152
    s_mov_b64 exec, -1
    s_branch Lexit
Lmow:
    s_mov_b64 exec, -1
Lw_14:
    ds_read_b64 v[4:5], v7 offset:14120
    s_add_u32 s52, s52, 1
    s_cmp_lt_u32 s52, 524288
    s_cbranch_scc0 Lexit
    s_waitcnt lgkmcnt(0)
    v_readfirstlane_b32 s44, v5
    v_readfirstlane_b32 s63, v4
    s_bitcmp1_b32 s44, 8
    s_cbranch_scc0 Lw_14
    s_mov_b64 exec, s[92:93]
    s_cmp_eq_u32 s63, 0
    s_cbranch_scc0 Lg_15
    buffer_store_dwordx4 v[100:103], v15, s[36:39], s58 offen
Le_16:
    s_branch Lmfin
Lhwait:
    ds_read_b32 v6, v7 offset:14136
    s_add_u32 s52, s52, 1
    s_cmp_lt_u32 s52, 524288
    s_cbranch_scc0 Lexit
    s_waitcnt lgkmcnt(0)
    v_readfirstlane_b32 s44, v6
    s_cmp_ge_u32 s44, 1
    s_cbranch_scc0 Lhwait
    s_branch Lhgo
Lhg_again:
    s_wqm_b64 exec, vcc
    buffer_load_dwordx4 v[32:35], v11, s[36:39], s47 offen sc1
    s_mov_b64 exec, -1
    s_add_u32 s52, s52, 1
    s_cmp_lt_u32 s52, 524288
    s_cbranch_scc0 Lexit
    s_waitcnt vmcnt(0)
    s_branch Lhg
Lg_15:
    buffer_store_dwordx4 v[100:103], v15, s[36:39], s58 offen sc1
    s_branch Le_16
Lagent:
    s_sub_u32 s53, s31, 28
    s_lshl_b32 s53, s53, 2
    s_lshl_b32 s44, s3, 0
    s_add_u32 s53, s53, s44
    s_lshl_b32 s45, s30, 17
    s_lshl_b32 s44, s53, 13
    s_add_u32 s45, s45, s44
    s_add_u32 s45, s45, 1048576
    s_add_u32 s46, s45, 4096
    s_lshl_b32 s47, s53, 11
    s_lshl_b32 s44, s30, 7
    s_add_u32 s47, s47, s44
    s_add_u32 s47, s47, 196608
    s_lshl_b32 s48, s53, 11
    s_lshl_b32 s44, s30, 2
    s_add_u32 s48, s48, s44
    s_add_u32 s48, s48, 32864
    v_lshrrev_b32 v4, 3, v1
    v_and_b32 v5, 7, v1
    v_lshlrev_b32 v94, 10, v4
    v_lshl_add_u32 v94, v5, 4, v94
Lw_17:
    ds_read_b32 v6, v7 offset:14128
    s_add_u32 s52, s52, 1
    s_cmp_lt_u32 s52, 524288
    s_cbranch_scc0 Lexit
    s_waitcnt lgkmcnt(0)
    v_readfirstlane_b32 s44, v6
    s_cmp_ge_u32 s44, 4
    s_cbranch_scc0 Lw_17
Lw_18:
    ds_read_b32 v6, v7 offset:14104
    s_add_u32 s52, s52, 1
    s_cmp_lt_u32 s52, 524288
    s_cbranch_scc0 Lexit
    s_waitcnt lgkmcnt(0)
    v_readfirstlane_b32 s44, v6
    s_cmp_ge_u32 s44, 4
    s_cbranch_scc0 Lw_18
    buffer_load_dwordx4 v[16:19], v111, s[36:39], s45 offen offset:0 sc1
    buffer_load_dwordx4 v[20:23], v111, s[36:39], s45 offen offset:1024 sc1
    buffer_load_dwordx4 v[24:27], v111, s[36:39], s45 offen offset:2048 sc1
    buffer_load_dwordx4 v[28:31], v111, s[36:39], s45 offen offset:3072 sc1
    buffer_load_dwordx4 v[32:35], v111, s[36:39], s46 offen offset:0 sc1
    buffer_load_dwordx4 v[36:39], v111, s[36:39], s46 offen offset:1024 sc1
    buffer_load_dwordx4 v[40:43], v111, s[36:39], s46 offen offset:2048 sc1
    buffer_load_dwordx4 v[44:47], v111, s[36:39], s46 offen offset:3072 sc1
Lw_19:
    ds_read_b32 v6, v7 offset:14144
    s_add_u32 s52, s52, 1
    s_cmp_lt_u32 s52, 524288
    s_cbranch_scc0 Lexit
    s_waitcnt lgkmcnt(0)
    v_readfirstlane_b32 s44, v6
    s_cmp_ge_u32 s44, 4
    s_cbranch_scc0 Lw_19
    s_setprio 2
    s_waitcnt vmcnt(0)
L2a:
    v_bitop3_b32 v4, v19, v23, v108 bitop3:0x7e
    v_bitop3_b32 v96, v27, v31, v108 bitop3:0x7e
    v_bitop3_b32 v97, v35, v39, v108 bitop3:0x7e
    v_bitop3_b32 v98, v43, v47, v108 bitop3:0x7e
    v_or3_b32 v4, v4, v96, v97
    v_or_b32 v4, v4, v98
    v_cmp_ne_u32 vcc, 0, v4
    s_cbranch_vccnz L2a_again
    s_mov_b64 exec, 1
    ds_add_u32 v7, v109 offset:14140
    s_mov_b64 exec, -1
    v_max3_f32 v4, v18, v22, v26
    v_max_f32 v4, v4, v30
    v_lshlrev_b32 v48, 16, v16
    v_and_b32 v49, 0xffff0000, v16
    v_max_f32 v4, v4, v4 row_ror:8 row_mask:0xf bank_mask:0xf
    v_mov_b32 v5, v4
    v_lshlrev_b32 v50, 16, v17
    v_and_b32 v51, 0xffff0000, v17
    v_permlane16_swap_b32 v5, v4
    v_max_f32 v4, v4, v5
    v_mov_b32 v5, v4
    v_lshlrev_b32 v52, 16, v20
    v_and_b32 v53, 0xffff0000, v20
    v_permlane32_swap_b32 v5, v4
    v_max_f32 v4, v4, v5
    v_sub_f32 v96, v18, v4
    v_sub_f32 v98, v22, v4
    v_sub_f32 v100, v26, v4
    v_sub_f32 v102, v30, v4
    v_exp_f32 v96, v96
    v_exp_f32 v98, v98
    v_exp_f32 v100, v100
    v_exp_f32 v102, v102
Lw_20:
    ds_read_b32 v6, v7 offset:14140
    v_lshlrev_b32 v54, 16, v21
    v_and_b32 v55, 0xffff0000, v21
    v_lshlrev_b32 v56, 16, v24
    v_and_b32 v57, 0xffff0000, v24
    v_lshlrev_b32 v58, 16, v25
    v_and_b32 v59, 0xffff0000, v25
    v_lshlrev_b32 v60, 16, v28
    v_and_b32 v61, 0xffff0000, v28
    v_lshlrev_b32 v62, 16, v29
    v_and_b32 v63, 0xffff0000, v29
    s_add_u32 s52, s52, 1
    s_cmp_lt_u32 s52, 524288
    s_cbranch_scc0 Lexit
    s_waitcnt lgkmcnt(0)
    v_readfirstlane_b32 s44, v6
    s_cmp_ge_u32 s44, 4
    s_cbranch_scc0 Lw_20
    s_mov_b64 exec, 3855
    buffer_store_dword v108, v91, s[36:39], s48 offen sc1
    s_mov_b64 exec, -1
    v_add_f32 v5, v96, v98
    v_add_f32 v6, v100, v102
    v_add_f32 v5, v5, v6
    v_lshlrev_b32 v64, 16, v32
    v_and_b32 v65, 0xffff0000, v32
    v_add_f32 v5, v5, v5 row_ror:8 row_mask:0xf bank_mask:0xf
    v_mov_b32 v6, v5
    v_lshlrev_b32 v66, 16, v33
    v_and_b32 v67, 0xffff0000, v33
    v_permlane16_swap_b32 v6, v5
    v_add_f32 v5, v5, v6
    v_mov_b32 v6, v5
    v_lshlrev_b32 v68, 16, v36
    v_and_b32 v69, 0xffff0000, v36
    v_permlane32_swap_b32 v6, v5
    v_add_f32 v5, v5, v6
    v_lshlrev_b32 v70, 16, v37
    v_and_b32 v71, 0xffff0000, v37
    v_lshlrev_b32 v72, 16, v40
    v_and_b32 v73, 0xffff0000, v40
    v_lshlrev_b32 v74, 16, v41
    v_and_b32 v75, 0xffff0000, v41
    v_lshlrev_b32 v76, 16, v44
    v_and_b32 v77, 0xffff0000, v44
    v_lshlrev_b32 v78, 16, v45
    v_and_b32 v79, 0xffff0000, v45
    v_rcp_f32 v5, v5
    v_pk_mul_f32 v[80:81], v[48:49], v[96:97] op_sel_hi:[1,0]
    v_pk_mul_f32 v[82:83], v[50:51], v[96:97] op_sel_hi:[1,0]
    v_pk_mul_f32 v[84:85], v[64:65], v[96:97] op_sel_hi:[1,0]
    v_pk_mul_f32 v[86:87], v[66:67], v[96:97] op_sel_hi:[1,0]
    v_pk_fma_f32 v[80:81], v[52:53], v[98:99], v[80:81] op_sel_hi:[1,0,1]
    v_pk_fma_f32 v[82:83], v[54:55], v[98:99], v[82:83] op_sel_hi:[1,0,1]
    v_pk_fma_f32 v[84:85], v[68:69], v[98:99], v[84:85] op_sel_hi:[1,0,1]
    v_pk_fma_f32 v[86:87], v[70:71], v[98:99], v[86:87] op_sel_hi:[1,0,1]
    v_pk_fma_f32 v[80:81], v[56:57], v[100:101], v[80:81] op_sel_hi:[1,0,1]
    v_pk_fma_f32 v[82:83], v[58:59], v[100:101], v[82:83] op_sel_hi:[1,0,1]
    v_pk_fma_f32 v[84:85], v[72:73], v[100:101], v[84:85] op_sel_hi:[1,0,1]
    v_pk_fma_f32 v[86:87], v[74:75], v[100:101], v[86:87] op_sel_hi:[1,0,1]
    v_pk_fma_f32 v[80:81], v[60:61], v[102:103], v[80:81] op_sel_hi:[1,0,1]
    v_pk_fma_f32 v[82:83], v[62:63], v[102:103], v[82:83] op_sel_hi:[1,0,1]
    v_pk_fma_f32 v[84:85], v[76:77], v[102:103], v[84:85] op_sel_hi:[1,0,1]
    v_pk_fma_f32 v[86:87], v[78:79], v[102:103], v[86:87] op_sel_hi:[1,0,1]
    v_permlane16_swap_b32 v80, v81
    v_permlane16_swap_b32 v82, v83
    v_permlane16_swap_b32 v84, v85
    v_permlane16_swap_b32 v86, v87
    v_add_f32 v80, v80, v81
    v_add_f32 v82, v82, v83
    v_add_f32 v84, v84, v85
    v_add_f32 v86, v86, v87
    v_permlane32_swap_b32 v80, v82
    v_mov_b32 v18, v108
    v_permlane32_swap_b32 v84, v86
    v_add_f32 v80, v80, v82
    v_add_f32 v84, v84, v86
    v_mov_b32 v19, v108
    v_add_f32 v4, v80, v80 row_ror:8 row_mask:0xf bank_mask:0x3
    s_nop 1
    v_add_f32 v4, v84, v84 row_ror:8 row_mask:0xf bank_mask:0xc
    v_mul_f32 v4, v4, v5
    v_mov_b32 v16, v4
    s_nop 1
    v_permlane16_swap_b32 v16, v4
    v_cvt_pk_bf16_f32 v17, v16, v4
    v_mov_b32 v16, v17
    s_nop 1
    v_permlane32_swap_b32 v16, v17
    s_mov_b64 exec, 0xffff
    buffer_store_dwordx4 v[16:19], v94, s[36:39], s47 offen sc1
    s_setprio 0
    s_mov_b64 exec, 1
    ds_add_u32 v7, v109 offset:14148
    s_mov_b64 exec, -1
    v_and_b32 v100, s51, v112
    v_and_b32 v101, s51, v112
    v_and_b32 v102, s51, v112
    v_and_b32 v103, s51, v112
    s_branch Lmow
L2a_again:
    s_wqm_b64 exec, vcc
    buffer_load_dwordx4 v[16:19], v111, s[36:39], s45 offen offset:0 sc1
    buffer_load_dwordx4 v[20:23], v111, s[36:39], s45 offen offset:1024 sc1
    buffer_load_dwordx4 v[24:27], v111, s[36:39], s45 offen offset:2048 sc1
    buffer_load_dwordx4 v[28:31], v111, s[36:39], s45 offen offset:3072 sc1
    buffer_load_dwordx4 v[32:35], v111, s[36:39], s46 offen offset:0 sc1
    buffer_load_dwordx4 v[36:39], v111, s[36:39], s46 offen offset:1024 sc1
    buffer_load_dwordx4 v[40:43], v111, s[36:39], s46 offen offset:2048 sc1
    buffer_load_dwordx4 v[44:47], v111, s[36:39], s46 offen offset:3072 sc1
    s_mov_b64 exec, -1
    s_add_u32 s52, s52, 1
    s_cmp_lt_u32 s52, 524288
    s_cbranch_scc0 Lexit
    s_waitcnt vmcnt(0)
    s_branch L2a
Lattn:
    s_load_dword s94, s[28:29], 0
    s_lshl_b32 s60, s30, 8
    s_lshl_b32 s44, s31, 3
    s_add_u32 s60, s60, s44
    v_lshlrev_b32 v4, 1, v2
    v_and_b32 v5, 1, v1
    v_lshl_add_u32 v156, v5, 11, v4
    v_add3_u32 v114, v156, v7, s60
    s_cmp_eq_u32 s3, 3
    s_cbranch_scc0 Lsm0
    s_mov_b32 s40, s22
    s_mov_b32 s41, s23
    s_mov_b32 s42, 2048
    buffer_load_ushort v106, v4, s[40:43], s60 offen
Lsm0:
    v_xor_b32 v8, v2, v3
    v_lshlrev_b32 v8, 4, v8
    v_lshl_add_u32 v8, v3, 8, v8
    s_lshl_b32 s44, s3, 13
    v_add_u32 v8, s44, v8
    v_xor_b32 v9, 64, v8
    v_xor_b32 v10, 128, v8
    v_xor_b32 v11, 192, v8
    v_lshrrev_b32 v12, 5, v1
    s_lshl_b32 s44, s3, 1
    v_add_u32 v12, s44, v12
    v_mul_u32_u24 v12, 288, v12
    v_and_b32 v6, 31, v1
    v_lshl_add_u32 v12, v6, 3, v12
    v_add_u32 v12, 131072, v12
    v_and_b32 v6, 7, v3
    v_mul_u32_u24 v13, 288, v6
    v_lshl_add_u32 v13, v2, 4, v13
    v_add_u32 v13, 131072, v13
    v_lshlrev_b32 v100, 4, v6
    v_add_u32 v100, 131072, v100
    v_lshl_add_u32 v15, v2, 7, v100
    v_and_b32 v14, 8, v3
    s_lshl_b32 s44, s3, 9
    v_add3_u32 v14, v14, v15, s44
    s_lshl_b32 s44, s3, 2
    v_add_u32 v101, s44, v100
    v_lshrrev_b32 v4, 2, v3
    v_lshl_add_u32 v4, v2, 2, v4
    v_and_b32 v5, 7, v4
    v_lshlrev_b32 v5, 1, v5
    v_bfe_u32 v102, v1, 1, 1
    v_add_u32 v102, s44, v102
    v_xor_b32 v102, v102, v5
    v_lshlrev_b32 v102, 4, v102
    v_lshl_add_u32 v102, v4, 8, v102
    v_and_b32 v5, 1, v1
    v_lshl_add_u32 v102, v5, 3, v102
    v_add_u32 v102, 65536, v102
    v_xor_b32 v103, 32, v102
    v_lshrrev_b32 v4, 3, v3
    v_lshl_add_u32 v4, v4, 2, v2
    v_lshlrev_b32 v4, 12, v4
    v_lshl_add_u32 v104, v6, 4, v4
    v_mov_b32 v113, 0x10000
    s_lshl_b32 s53, s30, 17
    s_lshl_b32 s44, s31, 7
    s_add_u32 s53, s53, s44
    s_lshl_b32 s44, s3, 15
    s_add_u32 s53, s53, s44
    s_add_u32 s53, s53, 1048576
    s_and_b32 s48, s2, 31
    s_lshl_b32 s48, s48, 7
    s_add_u32 s48, s48, 16384
    s_add_u32 s20, s28, s48
    s_addc_u32 s21, s29, 0
    s_lshl_b32 s45, s30, 14
    s_lshl_b32 s44, s3, 10
    s_add_u32 s45, s45, s44
    s_add_u32 s45, s45, 65536
    s_lshr_b32 s44, s30, 2
    s_lshl_b32 s44, s44, 13
    s_xor_b32 s47, s44, 8192
    s_add_u32 s47, s47, s45
    s_add_u32 s45, s45, s44
    s_add_u32 s46, s45, 4096
    s_add_u32 s48, s47, 4096
    s_getreg_b32 s58, hwreg(HW_REG_XCC_ID, 0, 4)
    s_mov_b32 s49, 0x3fb8aa3b
    s_mov_b32 s96, 0x3db504f3
    s_mov_b32 s97, s96
Lw_21:
    ds_read_b32 v6, v7 offset:14092
    ds_read_u16 v107, v114 offset:14464
    s_add_u32 s52, s52, 1
    s_cmp_lt_u32 s52, 524288
    s_cbranch_scc0 Lexit
    s_waitcnt lgkmcnt(0)
    v_readfirstlane_b32 s44, v6
    s_cmp_ge_u32 s44, 4
    s_cbranch_scc0 Lw_21
    s_add_u32 s94, s94, 0x9e3779b1
    s_mov_b32 s95, s94
    v_mov_b32 v108, s94
    v_and_b32 v4, s51, v108
    s_bfe_u32 s44, s58, 65536
    s_lshl_b32 s44, s44, 8
    v_or_b32 v152, s44, v4
    s_bfe_u32 s44, s58, 65537
    s_lshl_b32 s44, s44, 8
    v_or_b32 v153, s44, v4
    s_bfe_u32 s44, s58, 65538
    s_lshl_b32 s44, s44, 8
    v_or_b32 v154, s44, v4
    s_bfe_u32 s44, s58, 65539
    s_lshl_b32 s44, s44, 8
    v_or_b32 v155, s44, v4
    s_cmp_eq_u32 s3, 0
    s_cbranch_scc0 Lqwait
Lqh:
    s_load_dwordx16 s[4:19], s[20:21], 0 glc
    s_add_u32 s52, s52, 1
    s_cmp_lt_u32 s52, 524288
    s_cbranch_scc0 Lexit
    s_waitcnt lgkmcnt(0)
    s_xor_b64 s[4:5], s[4:5], s[94:95]
    s_xor_b64 s[6:7], s[6:7], s[94:95]
    s_xor_b64 s[8:9], s[8:9], s[94:95]
    s_xor_b64 s[10:11], s[10:11], s[94:95]
    s_xor_b64 s[12:13], s[12:13], s[94:95]
    s_xor_b64 s[14:15], s[14:15], s[94:95]
    s_xor_b64 s[16:17], s[16:17], s[94:95]
    s_xor_b64 s[18:19], s[18:19], s[94:95]
    s_or_b64 s[4:5], s[4:5], s[12:13]
    s_or_b64 s[6:7], s[6:7], s[14:15]
    s_or_b64 s[8:9], s[8:9], s[16:17]
    s_or_b64 s[10:11], s[10:11], s[18:19]
    s_or_b64 s[4:5], s[4:5], s[8:9]
    s_or_b64 s[6:7], s[6:7], s[10:11]
    s_or_b64 s[4:5], s[4:5], s[6:7]
    s_cbranch_scc1 Lqh
    s_mov_b64 exec, 1
    ds_add_u32 v7, v109 offset:14108
    s_mov_b64 exec, -1
Lqgo:
    buffer_load_dwordx4 v[80:83], v111, s[36:39], s45 offen sc1
    buffer_load_dwordx4 v[84:87], v111, s[36:39], s46 offen sc1
    buffer_load_dwordx4 v[88:91], v111, s[36:39], s47 offen sc1
    buffer_load_dwordx4 v[92:95], v111, s[36:39], s48 offen sc1
Lw_22:
    ds_read_b32 v6, v7 offset:14100
    s_add_u32 s52, s52, 1
    s_cmp_lt_u32 s52, 524288
    s_cbranch_scc0 Lexit
    s_waitcnt lgkmcnt(0)
    v_readfirstlane_b32 s44, v6
    s_cmp_ge_u32 s44, 4
    s_cbranch_scc0 Lw_22
    ds_read_b128 v[16:19], v8 offset:32768
    ds_read_b128 v[20:23], v9 offset:32768
    ds_read_b128 v[24:27], v10 offset:32768
    ds_read_b128 v[28:31], v11 offset:32768
    ds_read_b128 v[32:35], v8 offset:36864
    ds_read_b128 v[36:39], v9 offset:36864
    ds_read_b128 v[40:43], v10 offset:36864
    ds_read_b128 v[44:47], v11 offset:36864
    s_mov_b64 exec, 1
    ds_add_u32 v7, v109 offset:14104
    s_mov_b64 exec, -1
    s_setprio 3
    s_waitcnt vmcnt(0)
L1q:
    v_bitop3_b32 v8, v80, v84, v152 bitop3:0x7e
    v_bitop3_b32 v9, v81, v85, v153 bitop3:0x7e
    v_bitop3_b32 v10, v82, v86, v154 bitop3:0x7e
    v_bitop3_b32 v11, v83, v87, v155 bitop3:0x7e
    v_or3_b32 v4, v8, v9, v10
    v_or_b32 v4, v4, v11
    v_bitop3_b32 v5, v88, v89, v108 bitop3:0x7e
    v_bitop3_b32 v8, v90, v91, v108 bitop3:0x7e
    v_bitop3_b32 v9, v92, v93, v108 bitop3:0x7e
    v_bitop3_b32 v10, v94, v95, v108 bitop3:0x7e
    v_or3_b32 v5, v5, v8, v9
    v_or_b32 v5, v5, v10
    v_bitop3_b32 v5, v4, v5, s51 bitop3:0xa8
    v_cmp_ne_u32 vcc, 0, v5
    s_cbranch_vccnz L1q_again
    v_and_b32 v4, 0x100, v4
    v_and_b32 v80, s59, v80
    v_and_b32 v81, s59, v81
    v_and_b32 v82, s59, v82
    v_and_b32 v83, s59, v83
    v_and_b32 v84, s59, v84
    v_and_b32 v85, s59, v85
    v_and_b32 v86, s59, v86
    v_and_b32 v87, s59, v87
    v_and_b32 v88, s59, v88
    v_and_b32 v89, s59, v89
    v_and_b32 v90, s59, v90
    v_and_b32 v91, s59, v91
    v_and_b32 v92, s59, v92
    v_and_b32 v93, s59, v93
    v_and_b32 v94, s59, v94
    v_and_b32 v95, s59, v95
    v_cmp_ne_u32 vcc, 0, v4
    v_pk_add_f32 v[80:81], v[80:81], v[84:85]
    v_pk_add_f32 v[82:83], v[82:83], v[86:87]
    v_pk_add_f32 v[88:89], v[88:89], v[92:93]
    v_pk_add_f32 v[90:91], v[90:91], v[94:95]
    v_pk_add_f32 v[80:81], v[80:81], v[88:89]
    v_pk_add_f32 v[82:83], v[82:83], v[90:91]
    v_cvt_pk_bf16_f32 v80, v80, v81
    v_cvt_pk_bf16_f32 v81, v82, v83
    ds_write_b64 v12, v[80:81] offset:8192
    s_cbranch_vccnz Lnonloc
Lisloc:
    s_mov_b64 exec, 1
    ds_add_u32 v7, v109 offset:14112
    s_mov_b64 exec, -1
Lw_23:
    ds_read_b32 v6, v7 offset:14112
    s_add_u32 s52, s52, 1
    s_cmp_lt_u32 s52, 524288
    s_cbranch_scc0 Lexit
    s_waitcnt lgkmcnt(0)
    v_readfirstlane_b32 s44, v6
    s_cmp_ge_u32 s44, 4
    s_cbranch_scc0 Lw_23
    ds_read_b128 v[48:51], v13 offset:8192
    ds_read_b128 v[52:55], v13 offset:8256
    ds_read_b128 v[56:59], v13 offset:8320
    ds_read_b128 v[60:63], v13 offset:8384
    ds_read_b32 v105, v7 offset:14120
    ds_read_b32 v115, v7 offset:14116
    s_waitcnt lgkmcnt(5)
    v_mfma_f32_16x16x32_bf16 v[96:99], v[16:19], v[48:51], 0
    ds_read_b64_tr_b16 v[120:121], v102 offset:0
    ds_read_b64_tr_b16 v[122:123], v102 offset:4096
    v_mfma_f32_16x16x32_bf16 v[116:119], v[32:35], v[48:51], 0
    ds_read_b64_tr_b16 v[124:125], v103 offset:0
    ds_read_b64_tr_b16 v[126:127], v103 offset:4096
    s_waitcnt lgkmcnt(8)
    v_mfma_f32_16x16x32_bf16 v[96:99], v[20:23], v[52:55], v[96:99]
    ds_read_b64_tr_b16 v[128:129], v102 offset:8192
    ds_read_b64_tr_b16 v[130:131], v102 offset:12288
    v_mfma_f32_16x16x32_bf16 v[116:119], v[36:39], v[52:55], v[116:119]
    ds_read_b64_tr_b16 v[132:133], v103 offset:8192
    ds_read_b64_tr_b16 v[134:135], v103 offset:12288
    s_waitcnt lgkmcnt(11)
    v_mfma_f32_16x16x32_bf16 v[96:99], v[24:27], v[56:59], v[96:99]
    ds_read_b64_tr_b16 v[136:137], v102 offset:16384
    ds_read_b64_tr_b16 v[138:139], v102 offset:20480
    v_mfma_f32_16x16x32_bf16 v[116:119], v[40:43], v[56:59], v[116:119]
    ds_read_b64_tr_b16 v[140:141], v103 offset:16384
    ds_read_b64_tr_b16 v[142:143], v103 offset:20480
    s_waitcnt lgkmcnt(14)
    v_mfma_f32_16x16x32_bf16 v[96:99], v[28:31], v[60:63], v[96:99]
    ds_read_b64_tr_b16 v[144:145], v102 offset:24576
    ds_read_b64_tr_b16 v[146:147], v102 offset:28672
    v_mfma_f32_16x16x32_bf16 v[116:119], v[44:47], v[60:63], v[116:119]
    ds_read_b64_tr_b16 v[148:149], v103 offset:24576
    ds_read_b64_tr_b16 v[150:151], v103 offset:28672
    s_waitcnt lgkmcnt(14)
    v_readfirstlane_b32 s63, v105
    v_readfirstlane_b32 s61, v115
    s_and_b32 s61, s61, 4
    s_nop 1
    v_mov_b32 v96, v116 quad_perm:[0,1,2,3] row_mask:0xf bank_mask:0xc
    v_mov_b32 v97, v117 quad_perm:[0,1,2,3] row_mask:0xf bank_mask:0xc
    v_mov_b32 v98, v118 quad_perm:[0,1,2,3] row_mask:0xf bank_mask:0xc
    v_mov_b32 v99, v119 quad_perm:[0,1,2,3] row_mask:0xf bank_mask:0xc
    v_cvt_pk_bf16_f32 v96, 0, v96
    v_cvt_pk_bf16_f32 v97, 0, v97
    v_cvt_pk_bf16_f32 v98, 0, v98
    v_cvt_pk_bf16_f32 v99, 0, v99
    v_pk_mul_f32 v[96:97], v[96:97], s[96:97]
    v_pk_mul_f32 v[98:99], v[98:99], s[96:97]
    v_cvt_pk_bf16_f32 v96, 0, v96
    v_cvt_pk_bf16_f32 v97, 0, v97
    v_cvt_pk_bf16_f32 v98, 0, v98
    v_cvt_pk_bf16_f32 v99, 0, v99
    v_max3_f32 v4, v96, v97, v98
    v_max_f32 v4, v4, v99
    s_nop 1
    v_max_f32 v4, v4, v4 row_ror:8 row_mask:0xf bank_mask:0xf
    v_mov_b32 v5, v4
    s_nop 1
    v_permlane16_swap_b32 v5, v4
    v_max_f32 v4, v4, v5
    v_mov_b32 v5, v4
    s_nop 1
    v_permlane32_swap_b32 v5, v4
    v_max_f32 v4, v4, v5
    v_mul_f32 v4, s49, v4
    v_fma_f32 v96, v96, s49, -v4
    v_fma_f32 v97, v97, s49, -v4
    v_fma_f32 v98, v98, s49, -v4
    v_fma_f32 v99, v99, s49, -v4
    ds_write_b32 v101, v4 offset:12800
    v_exp_f32 v96, v96
    v_exp_f32 v97, v97
    v_exp_f32 v98, v98
    v_exp_f32 v99, v99
    v_add_f32 v5, v96, v97
    v_add_f32 v6, v98, v99
    v_add_f32 v5, v5, v6
    v_cvt_pk_bf16_f32 v96, v96, v97
    v_cvt_pk_bf16_f32 v97, v98, v99
    v_add_f32 v5, v5, v5 row_ror:8 row_mask:0xf bank_mask:0xf
    v_mov_b32 v6, v5
    ds_write_b64 v14, v[96:97] offset:10752
    s_nop 0
    v_permlane16_swap_b32 v6, v5
    v_add_f32 v5, v5, v6
    v_mov_b32 v6, v5
    s_nop 1
    v_permlane32_swap_b32 v6, v5
    v_add_f32 v5, v5, v6
    ds_write_b32 v101, v5 offset:12928
    s_mov_b64 exec, 1
    ds_add_u32 v7, v113 offset:14116
    s_mov_b64 exec, -1
Lvp:
    ds_read_b32 v6, v7 offset:14116
    s_add_u32 s52, s52, 1
    s_cmp_lt_u32 s52, 524288
    s_cbranch_scc0 Lexit
    s_waitcnt lgkmcnt(0)
    v_readfirstlane_b32 s44, v6
    s_andn2_b32 s44, s44, s61
    s_and_b32 s44, s44, 0x40004
    s_cbranch_scc0 Lvp
    s_or_b32 s61, s61, s44
    s_bitcmp1_b32 s44, 18
    s_cbranch_scc0 Lnop
    ds_read_b128 v[8:11], v100 offset:12800
    ds_read_b128 v[84:87], v100 offset:12928
    ds_read_b128 v[48:51], v15 offset:10752
    ds_read_b128 v[52:55], v15 offset:11264
    ds_read_b128 v[56:59], v15 offset:11776
    ds_read_b128 v[60:63], v15 offset:12288
Lnop:
    s_bitcmp1_b32 s44, 2
    s_cbranch_scc0 Lnov
    ds_read_b64_tr_b16 v[120:121], v102 offset:0
    ds_read_b64_tr_b16 v[122:123], v102 offset:4096
    ds_read_b64_tr_b16 v[124:125], v103 offset:0
    ds_read_b64_tr_b16 v[126:127], v103 offset:4096
    ds_read_b64_tr_b16 v[128:129], v102 offset:8192
    ds_read_b64_tr_b16 v[130:131], v102 offset:12288
    ds_read_b64_tr_b16 v[132:133], v103 offset:8192
    ds_read_b64_tr_b16 v[134:135], v103 offset:12288
    ds_read_b64_tr_b16 v[136:137], v102 offset:16384
    ds_read_b64_tr_b16 v[138:139], v102 offset:20480
    ds_read_b64_tr_b16 v[140:141], v103 offset:16384
    ds_read_b64_tr_b16 v[142:143], v103 offset:20480
    ds_read_b64_tr_b16 v[144:145], v102 offset:24576
    ds_read_b64_tr_b16 v[146:147], v102 offset:28672
    ds_read_b64_tr_b16 v[148:149], v103 offset:24576
    ds_read_b64_tr_b16 v[150:151], v103 offset:28672
Lnov:
    s_cmp_eq_u32 s61, 0x40004
    s_cbranch_scc0 Lvp
    s_waitcnt lgkmcnt(3)
    v_mfma_f32_16x16x32_bf16 v[16:19], v[120:123], v[48:51], 0
    v_max3_f32 v4, v8, v9, v10
    v_max_f32 v4, v4, v11
    v_mfma_f32_16x16x32_bf16 v[20:23], v[124:127], v[48:51], 0
    v_sub_f32 v8, v8, v4
    v_sub_f32 v9, v9, v4
    s_waitcnt lgkmcnt(2)
    v_mfma_f32_16x16x32_bf16 v[24:27], v[128:131], v[52:55], 0
    v_sub_f32 v10, v10, v4
    v_sub_f32 v11, v11, v4
    v_mfma_f32_16x16x32_bf16 v[28:31], v[132:135], v[52:55], 0
    v_exp_f32 v8, v8
    s_waitcnt lgkmcnt(1)
    v_mfma_f32_16x16x32_bf16 v[32:35], v[136:139], v[56:59], 0
    v_exp_f32 v9, v9
    v_mfma_f32_16x16x32_bf16 v[36:39], v[140:143], v[56:59], 0
    v_exp_f32 v10, v10
    s_waitcnt lgkmcnt(0)
    v_mfma_f32_16x16x32_bf16 v[40:43], v[144:147], v[60:63], 0
    v_exp_f32 v11, v11
    v_mfma_f32_16x16x32_bf16 v[44:47], v[148:151], v[60:63], 0
    v_mul_f32 v5, v8, v84
    v_fmac_f32 v5, v9, v85
    v_fmac_f32 v5, v10, v86
    v_fmac_f32 v5, v11, v87
    v_pk_mul_f32 v[92:93], v[20:21], v[8:9] op_sel_hi:[1,0]
    v_pk_mul_f32 v[94:95], v[22:23], v[8:9] op_sel_hi:[1,0]
    v_pk_mul_f32 v[88:89], v[16:17], v[8:9] op_sel_hi:[1,0]
    v_pk_mul_f32 v[90:91], v[18:19], v[8:9] op_sel_hi:[1,0]
    v_rcp_f32 v6, v5
    v_log_f32 v5, v5
    v_pk_fma_f32 v[92:93], v[28:29], v[8:9], v[92:93] op_sel:[0,1,0] op_sel_hi:[1,1,1]
    v_pk_fma_f32 v[94:95], v[30:31], v[8:9], v[94:95] op_sel:[0,1,0] op_sel_hi:[1,1,1]
    v_pk_fma_f32 v[88:89], v[24:25], v[8:9], v[88:89] op_sel:[0,1,0] op_sel_hi:[1,1,1]
    v_pk_fma_f32 v[90:91], v[26:27], v[8:9], v[90:91] op_sel:[0,1,0] op_sel_hi:[1,1,1]
    v_pk_fma_f32 v[92:93], v[36:37], v[10:11], v[92:93] op_sel_hi:[1,0,1]
    v_pk_fma_f32 v[94:95], v[38:39], v[10:11], v[94:95] op_sel_hi:[1,0,1]
    v_pk_fma_f32 v[88:89], v[32:33], v[10:11], v[88:89] op_sel_hi:[1,0,1]
    v_pk_fma_f32 v[90:91], v[34:35], v[10:11], v[90:91] op_sel_hi:[1,0,1]
    v_pk_fma_f32 v[92:93], v[44:45], v[10:11], v[92:93] op_sel:[0,1,0] op_sel_hi:[1,1,1]
    v_pk_fma_f32 v[94:95], v[46:47], v[10:11], v[94:95] op_sel:[0,1,0] op_sel_hi:[1,1,1]
    v_pk_fma_f32 v[88:89], v[40:41], v[10:11], v[88:89] op_sel:[0,1,0] op_sel_hi:[1,1,1]
    v_pk_fma_f32 v[90:91], v[42:43], v[10:11], v[90:91] op_sel:[0,1,0] op_sel_hi:[1,1,1]
    v_mov_b32 v83, v108
    v_mov_b32 v88, v92 quad_perm:[0,1,2,3] row_mask:0xf bank_mask:0xc
    v_mov_b32 v89, v93 quad_perm:[0,1,2,3] row_mask:0xf bank_mask:0xc
    v_mov_b32 v90, v94 quad_perm:[0,1,2,3] row_mask:0xf bank_mask:0xc
    v_mov_b32 v91, v95 quad_perm:[0,1,2,3] row_mask:0xf bank_mask:0xc
    v_add_f32 v82, v4, v5
    v_pk_mul_f32 v[88:89], v[88:89], v[6:7] op_sel_hi:[1,0]
    v_pk_mul_f32 v[90:91], v[90:91], v[6:7] op_sel_hi:[1,0]
    v_cvt_pk_bf16_f32 v80, v88, v89
    v_cvt_pk_bf16_f32 v81, v90, v91
    s_cmp_eq_u32 s63, 0
    s_cbranch_scc0 Lg_24
    buffer_store_dwordx4 v[80:83], v104, s[36:39], s53 offen
Le_25:
    s_mov_b64 exec, 1
    ds_add_u32 v7, v109 offset:14144
    s_mov_b64 exec, -1
    s_setprio 0
    v_lshrrev_b32 v4, 2, v3
    v_and_b32 v5, 1, v2
    v_lshl_add_u32 v5, v5, 2, v4
    v_lshlrev_b32 v5, 1, v5
    v_bfe_u32 v6, v1, 1, 1
    s_lshl_b32 s44, s3, 2
    v_add_u32 v6, s44, v6
    v_xor_b32 v8, v5, v6
    v_lshlrev_b32 v8, 4, v8
    v_lshl_add_u32 v4, v2, 3, v4
    v_lshl_add_u32 v8, v4, 8, v8
    v_and_b32 v5, 1, v1
    v_lshl_add_u32 v8, v5, 3, v8
    v_xor_b32 v9, 32, v8
    v_and_b32 v4, 1, v1
    v_lshlrev_b32 v13, 8, v4
    v_lshl_add_u32 v13, v2, 4, v13
    v_add_u32 v13, 131072, v13
    v_bfe_u32 v5, v1, 1, 1
    v_lshl_add_u32 v5, v5, 2, v2
    v_lshlrev_b32 v5, 6, v5
    v_lshl_add_u32 v15, v4, 4, v5
    v_add_u32 v112, 64, v108
    s_mov_b32 s56, 0x000c000c
    s_mov_b32 s57, s56
    s_mov_b32 s92, 0x000f000f
    s_mov_b32 s93, s92
    s_lshl_b32 s58, s30, 17
    s_lshl_b32 s44, s3, 9
    s_add_u32 s58, s58, s44
    s_lshl_b32 s44, s31, 12
    s_add_u32 s58, s58, s44
    s_add_u32 s58, s58, 1048576
    v_lshlrev_b32 v97, 16, v106
    v_lshlrev_b32 v98, 16, v107
    v_lshrrev_b32 v12, 2, v1
    v_lshlrev_b32 v12, 12, v12
    v_and_b32 v6, 3, v1
    v_lshl_add_u32 v12, v6, 4, v12
    s_mov_b32 s40, s24
    s_mov_b32 s41, s25
    s_mov_b32 s42, 4096
    s_lshl_b32 s45, s30, 17
    s_lshl_b32 s44, s31, 6
    s_add_u32 s45, s45, s44
    s_add_u32 s45, s45, 1048576
    s_add_u32 s46, s45, 65536
    s_cmp_eq_u32 s3, 0
    s_cbranch_scc0 Lnoto
    s_lshl_b32 s47, s31, 10
    s_add_u32 s47, s47, 196608
    s_and_b32 s48, s55, 251
    s_lshl_b32 s48, s48, 7
    s_add_u32 s48, s48, 32768
    s_add_u32 s20, s28, s48
    s_addc_u32 s21, s29, 0
    v_lshl_add_u32 v10, v1, 3, v7
    v_mov_b32 v113, 0x100
Loh:
    s_load_dwordx8 s[4:11], s[20:21], 96 glc
    s_add_u32 s52, s52, 1
    s_cmp_lt_u32 s52, 524288
    s_cbranch_scc0 Lexit
    s_waitcnt lgkmcnt(0)
    s_xor_b64 s[4:5], s[4:5], s[94:95]
    s_xor_b64 s[6:7], s[6:7], s[94:95]
    s_xor_b64 s[8:9], s[8:9], s[94:95]
    s_xor_b64 s[10:11], s[10:11], s[94:95]
    s_or_b64 s[4:5], s[4:5], s[8:9]
    s_or_b64 s[6:7], s[6:7], s[10:11]
    s_or_b64 s[4:5], s[4:5], s[6:7]
    s_cbranch_scc1 Loh
    buffer_load_dwordx4 v[84:87], v111, s[36:39], s47 offen sc1
    s_mov_b64 exec, 1
    ds_add_u32 v7, v109 offset:14132
    s_mov_b64 exec, -1
Lnoto:
Lw_26:
    ds_read_b32 v6, v7 offset:14132
    s_add_u32 s52, s52, 1
    s_cmp_lt_u32 s52, 524288
    s_cbranch_scc0 Lexit
    s_waitcnt lgkmcnt(0)
    v_readfirstlane_b32 s44, v6
    s_cmp_ge_u32 s44, 5
    s_cbranch_scc0 Lw_26
    ds_read_b64_tr_b16 v[16:17], v8 offset:0
    ds_read_b64_tr_b16 v[18:19], v8 offset:1024
    ds_read_b64_tr_b16 v[20:21], v8 offset:8192
    ds_read_b64_tr_b16 v[22:23], v8 offset:9216
    ds_read_b64_tr_b16 v[24:25], v8 offset:16384
    ds_read_b64_tr_b16 v[26:27], v8 offset:17408
    ds_read_b64_tr_b16 v[28:29], v8 offset:24576
    ds_read_b64_tr_b16 v[30:31], v8 offset:25600
    ds_read_b64_tr_b16 v[32:33], v9 offset:0
    ds_read_b64_tr_b16 v[34:35], v9 offset:1024
    ds_read_b64_tr_b16 v[36:37], v9 offset:8192
    ds_read_b64_tr_b16 v[38:39], v9 offset:9216
    ds_read_b64_tr_b16 v[40:41], v9 offset:16384
    ds_read_b64_tr_b16 v[42:43], v9 offset:17408
    ds_read_b64_tr_b16 v[44:45], v9 offset:24576
    ds_read_b64_tr_b16 v[46:47], v9 offset:25600
    s_setprio 2
    s_cmp_eq_u32 s3, 0
    s_cbranch_scc0 Low
    s_waitcnt vmcnt(0)
Log:
    v_cmp_ne_u32 vcc, v87, v108
    s_cbranch_vccnz Log_again
    ds_write_b64 v10, v[84:85] offset:13056
    s_mov_b64 exec, 1
    ds_add_u32 v7, v113 offset:14124
    s_mov_b64 exec, -1
Low:
    ds_read_b32 v4, v7 offset:14124
    ds_read_b128 v[48:51], v13 offset:13056
    ds_read_b128 v[52:55], v13 offset:13120
    ds_read_b128 v[56:59], v13 offset:13184
    ds_read_b128 v[60:63], v13 offset:13248
    s_add_u32 s52, s52, 1
    s_cmp_lt_u32 s52, 524288
    s_cbranch_scc0 Lexit
    s_waitcnt lgkmcnt(4)
    v_readfirstlane_b32 s44, v4
    s_bitcmp1_b32 s44, 8
    s_cbranch_scc0 Low
    s_waitcnt lgkmcnt(3)
    v_mfma_f32_16x16x32_bf16 v[64:67], v[16:19], v[48:51], 0
    s_waitcnt lgkmcnt(2)
    v_mfma_f32_16x16x32_bf16 v[64:67], v[20:23], v[52:55], v[64:67]
    s_waitcnt lgkmcnt(1)
    v_mfma_f32_16x16x32_bf16 v[64:67], v[24:27], v[56:59], v[64:67]
    s_waitcnt lgkmcnt(0)
    v_mfma_f32_16x16x32_bf16 v[64:67], v[28:31], v[60:63], v[64:67]
    v_mfma_f32_16x16x32_bf16 v[68:71], v[32:35], v[48:51], 0
    v_mfma_f32_16x16x32_bf16 v[68:71], v[36:39], v[52:55], v[68:71]
    v_mfma_f32_16x16x32_bf16 v[68:71], v[40:43], v[56:59], v[68:71]
    v_mfma_f32_16x16x32_bf16 v[68:71], v[44:47], v[60:63], v[68:71]
    s_cmp_eq_u32 s63, 0
    s_nop 2
    v_bfi_b32 v72, s50, v64, v112
    v_bfi_b32 v73, s50, v65, v112
    v_bfi_b32 v74, s50, v66, v112
    v_bfi_b32 v75, s50, v67, v112
    s_mov_b64 exec, s[56:57]
    v_bfi_b32 v72, s50, v68, v112
    v_bfi_b32 v73, s50, v69, v112
    v_bfi_b32 v74, s50, v70, v112
    v_bfi_b32 v75, s50, v71, v112
    s_mov_b64 exec, s[92:93]
    s_cbranch_scc0 Lg_27
    buffer_store_dwordx4 v[72:75], v15, s[36:39], s58 offen
Le_28:
    s_cmp_eq_u32 s3, 3
    s_cbranch_scc0 Lnocons
    s_mov_b64 exec, -1
Lw_29:
    ds_read_b32 v6, v7 offset:14152
    s_add_u32 s52, s52, 1
    s_cmp_lt_u32 s52, 524288
    s_cbranch_scc0 Lexit
    s_waitcnt lgkmcnt(0)
    v_readfirstlane_b32 s44, v6
    s_cmp_ge_u32 s44, 4
    s_cbranch_scc0 Lw_29
    buffer_load_dwordx4 v[16:19], v12, s[36:39], s45 offen sc1
    buffer_load_dwordx4 v[20:23], v12, s[36:39], s46 offen sc1
    s_waitcnt vmcnt(0)
Lfp:
    v_bitop3_b32 v4, v16, v17, v112 bitop3:0x7e
    v_bitop3_b32 v40, v18, v19, v112 bitop3:0x7e
    v_bitop3_b32 v41, v20, v21, v112 bitop3:0x7e
    v_or3_b32 v4, v4, v40, v41
    v_bitop3_b32 v40, v22, v23, v112 bitop3:0x7e
    v_bitop3_b32 v4, v4, v40, s51 bitop3:0xa8
    v_cmp_ne_u32 vcc, 0, v4
    s_cbranch_vccnz Lfp_again
    v_and_b32 v32, s50, v16
    v_and_b32 v33, s50, v17
    v_and_b32 v34, s50, v18
    v_and_b32 v35, s50, v19
    v_and_b32 v36, s50, v20
    v_and_b32 v37, s50, v21
    v_and_b32 v38, s50, v22
    v_and_b32 v39, s50, v23
    v_pk_add_f32 v[32:33], v[32:33], v[36:37]
    v_pk_add_f32 v[34:35], v[34:35], v[38:39]
    s_nop 0
    v_permlane16_swap_b32 v32, v33
    v_permlane16_swap_b32 v34, v35
    v_add_f32 v32, v32, v33
    v_add_f32 v34, v34, v35
    s_nop 1
    v_permlane32_swap_b32 v32, v34
    v_add_f32 v32, v32, v34
    s_nop 1
    v_add_f32 v32, v32, v32 row_ror:4 row_mask:0xf bank_mask:0xf
    s_nop 1
    v_add_f32 v32, v32, v32 row_ror:8 row_mask:0xf bank_mask:0xf
    v_cvt_pk_bf16_f32 v32, 0, v32
    s_nop 1
    v_add_f32 v33, v32, v97 quad_perm:[2,3,2,3] row_mask:0xf bank_mask:0xf
    v_cvt_pk_bf16_f32 v33, 0, v33
    v_mul_f32 v34, 0xbfb8aa3b, v33
    v_exp_f32 v34, v34
    s_mov_b32 exec_lo, 0x00030003
    v_add_f32 v34, 1.0, v34
    v_rcp_f32 v34, v34
    s_mov_b32 exec_hi, 0x00030003
    v_mul_f32 v33, v33, v34
    v_cvt_pk_bf16_f32 v33, 0, v33
    v_mul_f32 v32, v32, v33
    v_cvt_pk_bf16_f32 v32, 0, v32
    v_add_f32 v32, v32, v98
    v_cvt_pk_bf16_f32 v32, v32, v32
    buffer_store_short v32, v156, s[40:43], s60 offen
Lexit:
Lend:
    s_endpgm
Lqwait:
    ds_read_b32 v6, v7 offset:14108
    s_add_u32 s52, s52, 1
    s_cmp_lt_u32 s52, 524288
    s_cbranch_scc0 Lexit
    s_waitcnt lgkmcnt(0)
    v_readfirstlane_b32 s44, v6
    s_cmp_ge_u32 s44, 1
    s_cbranch_scc0 Lqwait
    s_branch Lqgo
L1q_again:
    s_wqm_b64 exec, vcc
    buffer_load_dwordx4 v[80:83], v111, s[36:39], s45 offen sc1
    buffer_load_dwordx4 v[84:87], v111, s[36:39], s46 offen sc1
    buffer_load_dwordx4 v[88:91], v111, s[36:39], s47 offen sc1
    buffer_load_dwordx4 v[92:95], v111, s[36:39], s48 offen sc1
    s_mov_b64 exec, -1
    s_add_u32 s52, s52, 1
    s_cmp_lt_u32 s52, 524288
    s_cbranch_scc0 Lexit
    s_waitcnt vmcnt(0)
    s_branch L1q
Lnonloc:
    s_mov_b64 exec, 1
    ds_add_u32 v7, v109 offset:14120
    s_mov_b64 exec, -1
    s_branch Lisloc
Lg_24:
    buffer_store_dwordx4 v[80:83], v104, s[36:39], s53 offen sc1
    s_branch Le_25
Log_again:
    s_wqm_b64 exec, vcc
    buffer_load_dwordx4 v[84:87], v111, s[36:39], s47 offen sc1
    s_mov_b64 exec, -1
    s_add_u32 s52, s52, 1
    s_cmp_lt_u32 s52, 524288
    s_cbranch_scc0 Lexit
    s_waitcnt vmcnt(0)
    s_branch Log
Lg_27:
    buffer_store_dwordx4 v[72:75], v15, s[36:39], s58 offen sc1
    s_branch Le_28
Lnocons:
    s_or_b32 s44, s2, s3
    s_cbranch_scc1 Lexit
    s_mov_b64 exec, 1
    buffer_store_dword v108, v111, s[36:39], 0 offen
    s_branch Lexit
Lfp_again:
    s_wqm_b64 exec, vcc
    buffer_load_dwordx4 v[16:19], v12, s[36:39], s45 offen sc1
    buffer_load_dwordx4 v[20:23], v12, s[36:39], s46 offen sc1
    s_mov_b64 exec, -1
    s_add_u32 s52, s52, 1
    s_cmp_lt_u32 s52, 524288
    s_cbranch_scc0 Lexit
    s_waitcnt vmcnt(4)
    s_branch Lfp
Lstop:
.if (Lstop-Lpc) < 12440
.fill (12440-(Lstop-Lpc))/4, 4, 0xbf810000
.endif
.section .rodata,"a"
.p2align 6
.amdhsa_kernel recurrent_scan__sliding_block_cached__mixer_channel_mlp__decode_kernel
  .amdhsa_next_free_vgpr 160
  .amdhsa_next_free_sgpr 102
  .amdhsa_accum_offset 160
  .amdhsa_group_segment_fixed_size 0
  .amdhsa_kernarg_size 104
  .amdhsa_user_sgpr_count 2
  .amdhsa_user_sgpr_kernarg_segment_ptr 1
  .amdhsa_system_sgpr_workgroup_id_x 1
  .amdhsa_float_denorm_mode_32 3
.end_amdhsa_kernel
```
